```python
import torch

def _softmax(x, axis=-1):
    return torch.softmax(x, dim=axis)
def _gelu(x):
    return torch.nn.functional.gelu(x, approximate="tanh")
def _silu(x):
    return torch.nn.functional.silu(x)
def _sigmoid(x):
    return torch.sigmoid(x)
def _layernorm(x, axis=-1, eps=1e-5):
    m = x.mean(dim=axis, keepdim=True)
    v = x.var(dim=axis, keepdim=True, unbiased=False)
    return (x - m) / torch.sqrt(v + eps)
def _scatter_add(tgt, idx, src, axis=0):
    return tgt.clone().index_add_(axis, idx, src)
def _segment_sum(src, seg, n):
    out = torch.zeros((n,) + src.shape[1:], dtype=src.dtype)
    return out.index_add_(0, seg, src)
def _pad(x, pw):
    flat = tuple(v for pair in reversed(pw) for v in pair)
    return torch.nn.functional.pad(x, flat)

kernel_name = 'gated_mix__mha_block__dense_activation_relu__prompt'

def setup_inputs():

    _w = (lambda a: (lambda t: t.to(torch.bfloat16) if t.is_floating_point() else t)(torch.as_tensor(a)))
    def _A_setup():
        B, S, D, H = 1, 2048, 512, 32
        return {
            "x": _w((lambda *s: torch.randn(*s, dtype=torch.bfloat16) * 0.05)(B, S, D)),
            "wqkv": _w((lambda *s: torch.randn(*s, dtype=torch.bfloat16) * 0.8)(D, 3 * D)),
            "wo": _w((lambda *s: torch.randn(*s, dtype=torch.bfloat16) * 0.2)(D, D)),
        }
    _A_in = _A_setup()

    def _B_setup():
        B, S, D, Dff = 1, 2048, 512, 1792
        return {
            "x": _w((lambda *s: torch.randn(*s, dtype=torch.bfloat16) * 0.05)(B, S, D)),
            "w1": _w((lambda *s: torch.randn(*s, dtype=torch.bfloat16) * 0.05)(D, Dff)),
            "w2": _w((lambda *s: torch.randn(*s, dtype=torch.bfloat16) * 0.05)(Dff, D)),
        }
    _B_in = _B_setup()

    return {
        "A_x": _A_in["x"],
        "A_wqkv": _A_in["wqkv"],
        "A_wo": _A_in["wo"],
        "B_x": _B_in["x"],
        "B_w1": _B_in["w1"],
        "B_w2": _B_in["w2"],
        "gate_w": _w((lambda *s: torch.randn(*s, dtype=torch.bfloat16) * 0.05)(512) * 16.0),
    }

def reference(A_x, A_wqkv, A_wo, B_x, B_w1, B_w2, gate_w):
    def _A_ref(x, wqkv, wo):
        B, S, D = x.shape
        H = 32
        Dh = D // H
        qkv = (lambda x, *d: x.permute(*d))((x @ wqkv).reshape(B, S, 3, H, Dh), 2, 0, 3, 1, 4)
        q, k, v = qkv[0], qkv[1], qkv[2]
        scores = torch.einsum("bhqd,bhkd->bhqk", q, k) * (Dh ** -0.5)
        p = _softmax(scores, axis=-1)
        o = torch.einsum("bhqk,bhkd->bhqd", p, v)
        return (lambda x, *d: x.permute(*d))(o, 0, 2, 1, 3).reshape(B, S, D) @ wo

    def _B_ref(x, w1, w2):
        h = torch.einsum("bsd,df->bsf", x, w1)
        zero = torch.zeros_like(h)
        h = torch.maximum(h, zero)
        return torch.einsum("bsf,fd->bsd", h, w2)

    x = A_x
    g = _sigmoid((x * gate_w).sum(-1, keepdims=True))
    a = _A_ref(x, A_wqkv, A_wo)
    b = _B_ref(x, B_w1, B_w2)
    return g * a + (1 - g) * b
```

```asm
; @launch grid=(256,1,1) block=(512,1,1) lds=163840
.amdgcn_target "amdgcn-amd-amdhsa--gfx950"
.text
.globl gated_mix__mha_block__dense_activation_relu__prompt_kernel
.p2align 8
.type gated_mix__mha_block__dense_activation_relu__prompt_kernel,@function
gated_mix__mha_block__dense_activation_relu__prompt_kernel:
    s_cmp_ge_u32 s2, 256
    s_cbranch_scc1 M_END
    s_load_dwordx4 s[48:51], s[0:1], 0
    s_load_dwordx2 s[52:53], s[0:1], 16
    s_load_dwordx4 s[56:59], s[0:1], 32
    s_load_dwordx4 s[60:63], s[0:1], 48
    s_load_dwordx4 s[76:79], s[0:1], 64
    s_getpc_b64 s[40:41]
M_PC:
    v_lshlrev_b32 v2, 6, v0
    v_min_u32 v2, M_END-M_PC, v2
    global_load_dword v23, v2, s[40:41]
    v_lshrrev_b32 v1, 6, v0
    v_and_b32 v0, 63, v0
    s_and_b32 s32, s2, 7
    v_readfirstlane_b32 s37, v1
    s_lshr_b32 s33, s2, 3
    s_lshr_b32 s34, s32, 1
    s_lshl_b32 s34, s34, 3
    s_and_b32 s40, s33, 7
    s_add_u32 s34, s34, s40
    s_and_b32 s35, s32, 1
    s_lshl_b32 s35, s35, 2
    s_lshr_b32 s40, s33, 3
    s_add_u32 s35, s35, s40
    s_and_b32 s36, s37, 3
    s_lshr_b32 s38, s34, 3
    s_and_b32 s39, s34, 7
    v_lshlrev_b32 v1, 4, v0
    s_lshr_b32 s98, s34, 2
    s_and_b32 s40, s34, 1
    s_lshl_b32 s94, s98, 1
    s_add_u32 s94, s94, s40
    s_and_b32 s40, s34, 3
    s_lshl_b32 s95, s35, 2
    s_add_u32 s95, s95, s40
    s_lshr_b32 s83, s95, 1
    s_mul_i32 s40, s98, 4
    s_add_u32 s83, s83, s40
    s_mul_i32 s40, s95, 0
    s_add_u32 s83, s83, s40
    s_and_b32 s83, s83, 7
    s_cmp_ge_u32 s37, 4
    s_cbranch_scc1 M_MAIN
    s_setprio 1
    v_lshrrev_b32 v4, 3, v0
    s_lshl_b32 s41, s36, 3
    v_add_u32 v4, s41, v4
    v_lshrrev_b32 v2, 4, v0
    s_and_b32 s40, s36, 1
    s_lshl_b32 s40, s40, 2
    v_and_b32 v3, 7, v0
    v_and_b32 v6, 1, v2
    v_lshlrev_b32 v6, 1, v6
    v_or_b32 v6, s40, v6
    v_xor_b32 v6, v6, v3
    v_lshlrev_b32 v6, 4, v6
    v_mul_u32_u24 v5, 3072, v4
    s_lshl_b32 s45, s98, 7
    v_add3_u32 v11, v5, v6, s45
    v_xor_b32 v12, 16, v11
    v_add_u32 v2, s40, v2
    v_xor_b32 v2, v2, v3
    v_lshlrev_b32 v2, 4, v2
    v_lshlrev_b32 v5, 10, v4
    s_lshl_b32 s40, s95, 16
    v_add3_u32 v10, v2, v5, s40
    s_lshl_b32 s42, s36, 10
    v_xor_b32 v13, 0x10000, v10
    v_mul_u32_u24 v5, 3584, v4
    s_lshl_b32 s40, s94, 8
    s_cmp_lt_u32 s94, 14
    s_cselect_b32 s40, s40, 0x40000000
    s_cselect_b32 s99, 0, 0x2000
    s_add_u32 s99, s99, s42
    v_add3_u32 v14, v5, v6, s40
    v_bfe_u32 v2, v0, 3, 2
    v_bfe_u32 v3, v0, 1, 2
    v_lshl_add_u32 v2, v2, 3, v3
    s_lshr_b32 s40, s36, 1
    s_lshl_b32 s96, s40, 3
    s_and_b32 s40, s36, 1
    s_add_u32 s96, s96, s40
    s_lshl_b32 s40, s96, 2
    v_add_lshl_u32 v40, v2, s40, 1
    s_lshl_b32 s96, s96, 9
    s_cmp_eq_u32 s94, 14
    s_cselect_b64 vcc, -1, 0
    s_waitcnt lgkmcnt(0)
    s_mov_b32 s64, s60
    s_and_b32 s65, s61, 0xffff
    s_mov_b32 s66, 0x400
    s_mov_b32 s67, 0x00020000
    s_mov_b32 s8, s48
    s_and_b32 s9, s49, 0xffff
    s_mov_b32 s10, 0x200000
    s_mov_b32 s11, 0x00020000
    s_mov_b32 s20, s56
    s_and_b32 s21, s57, 0xffff
    s_mov_b32 s22, 0x1c0000
    s_mov_b32 s23, 0x00020000
    s_mov_b32 s12, s50
    s_and_b32 s13, s51, 0xffff
    s_mov_b32 s14, 0x180000
    s_mov_b32 s15, 0x00020000
    s_add_u32 s84, s83, 0
    s_and_b32 s84, s84, 7
    s_lshl_b32 s43, s84, 7
    s_mul_i32 s44, s84, 229376
    s_add_u32 s45, s44, 114688
    s_add_u32 m0, s42, 0
    s_nop 0
    buffer_load_dwordx4 v10, s[8:11], s43 offen lds
    s_add_u32 m0, s42, 65536
    s_nop 0
    buffer_load_dwordx4 v13, s[8:11], s43 offen lds
    s_cbranch_vccnz A_GD0
    s_add_u32 m0, s99, 73728
    s_nop 0
    buffer_load_dwordx4 v14, s[20:23], s44 offen offset:0 lds
A_GE0:
    s_add_u32 m0, s42, 81792
    s_nop 0
    buffer_load_dwordx4 v14, s[20:23], s44 offen offset:128 lds
    s_add_u32 s43, s43, 32768
    s_add_u32 m0, s42, 4096
    s_nop 0
    buffer_load_dwordx4 v10, s[8:11], s43 offen lds
    s_add_u32 m0, s42, 69632
    s_nop 0
    buffer_load_dwordx4 v13, s[8:11], s43 offen lds
    s_add_u32 m0, s99, 77824
    s_nop 0
    buffer_load_dwordx4 v14, s[20:23], s45 offen offset:0 lds
    s_add_u32 m0, s42, 85888
    s_nop 0
    buffer_load_dwordx4 v14, s[20:23], s45 offen offset:128 lds
    s_add_u32 s84, s83, 0
    s_and_b32 s84, s84, 7
    s_lshl_b32 s43, s84, 7
    s_mul_i32 s44, s84, 196608
    s_add_u32 s45, s44, 98304
    s_add_u32 m0, s42, 90112
    s_nop 0
    buffer_load_dwordx4 v11, s[12:15], s44 offen offset:0 lds
    s_add_u32 m0, s42, 97280
    s_nop 0
    buffer_load_dwordx4 v12, s[12:15], s44 offen offset:1024 lds
    s_add_u32 m0, s42, 104448
    s_nop 0
    buffer_load_dwordx4 v11, s[12:15], s44 offen offset:2048 lds
    s_add_u32 s43, s43, 32768
    s_add_u32 m0, s42, 94208
    s_nop 0
    buffer_load_dwordx4 v11, s[12:15], s45 offen offset:0 lds
    s_add_u32 m0, s42, 101376
    s_nop 0
    buffer_load_dwordx4 v12, s[12:15], s45 offen offset:1024 lds
    s_add_u32 m0, s42, 108544
    s_nop 0
    buffer_load_dwordx4 v11, s[12:15], s45 offen offset:2048 lds
    s_waitcnt vmcnt(6)
    s_barrier
    s_add_u32 s84, s83, 1
    s_and_b32 s84, s84, 7
    s_lshl_b32 s43, s84, 7
    s_mul_i32 s44, s84, 196608
    s_add_u32 s45, s44, 98304
    s_add_u32 m0, s42, 8192
    s_nop 0
    buffer_load_dwordx4 v10, s[8:11], s43 offen lds
    s_add_u32 m0, s42, 114688
    s_nop 0
    buffer_load_dwordx4 v11, s[12:15], s44 offen offset:0 lds
    s_add_u32 m0, s42, 121856
    s_nop 0
    buffer_load_dwordx4 v12, s[12:15], s44 offen offset:1024 lds
    s_add_u32 m0, s42, 129024
    s_nop 0
    buffer_load_dwordx4 v11, s[12:15], s44 offen offset:2048 lds
    s_add_u32 s43, s43, 32768
    s_add_u32 m0, s42, 12288
    s_nop 0
    buffer_load_dwordx4 v10, s[8:11], s43 offen lds
    s_add_u32 m0, s42, 118784
    s_nop 0
    buffer_load_dwordx4 v11, s[12:15], s45 offen offset:0 lds
    s_add_u32 m0, s42, 125952
    s_nop 0
    buffer_load_dwordx4 v12, s[12:15], s45 offen offset:1024 lds
    s_add_u32 m0, s42, 133120
    s_nop 0
    buffer_load_dwordx4 v11, s[12:15], s45 offen offset:2048 lds
    s_waitcnt vmcnt(8)
    s_barrier
    s_add_u32 s84, s83, 2
    s_and_b32 s84, s84, 7
    s_lshl_b32 s43, s84, 7
    s_mul_i32 s44, s84, 196608
    s_add_u32 s45, s44, 98304
    s_add_u32 m0, s42, 16384
    s_nop 0
    buffer_load_dwordx4 v10, s[8:11], s43 offen lds
    s_add_u32 m0, s42, 139264
    s_nop 0
    buffer_load_dwordx4 v11, s[12:15], s44 offen offset:0 lds
    s_add_u32 m0, s42, 146432
    s_nop 0
    buffer_load_dwordx4 v12, s[12:15], s44 offen offset:1024 lds
    s_add_u32 m0, s42, 153600
    s_nop 0
    buffer_load_dwordx4 v11, s[12:15], s44 offen offset:2048 lds
    s_add_u32 s43, s43, 32768
    s_add_u32 m0, s42, 20480
    s_nop 0
    buffer_load_dwordx4 v10, s[8:11], s43 offen lds
    s_add_u32 m0, s42, 143360
    s_nop 0
    buffer_load_dwordx4 v11, s[12:15], s45 offen offset:0 lds
    s_add_u32 m0, s42, 150528
    s_nop 0
    buffer_load_dwordx4 v12, s[12:15], s45 offen offset:1024 lds
    s_add_u32 m0, s42, 157696
    s_nop 0
    buffer_load_dwordx4 v11, s[12:15], s45 offen offset:2048 lds
    s_mov_b32 s24, s58
    s_and_b32 s25, s59, 0xffff
    s_mov_b32 s26, 0x1c0000
    s_mov_b32 s27, 0x00020000
    s_mov_b32 s28, s52
    s_and_b32 s29, s53, 0xffff
    s_mov_b32 s30, 0x80000
    s_mov_b32 s31, 0x00020000
    s_mov_b32 s68, s62
    s_and_b32 s69, s63, 0xffff
    s_mov_b32 s70, 0x200000
    s_mov_b32 s71, 0x00020000
    s_mov_b32 s16, s78
    s_and_b32 s17, s79, 0xffff
    s_mov_b32 s18, 0x116a000
    s_mov_b32 s19, 0x00020000
    s_mov_b32 s72, s76
    s_and_b32 s73, s77, 0xffff
    s_mov_b32 s74, 0x100
    s_mov_b32 s75, 0x00020000
    v_lshlrev_b32 v39, 9, v0
    s_lshl_b32 s41, s34, 12
    s_lshl_b32 s40, s36, 7
    s_add_u32 s41, s41, s40
    s_add_u32 s41, s41, 18087936
    v_add_u32 v39, s41, v39
    v_lshlrev_b32 v43, 2, v0
    v_add_u32 v43, 135168, v43
    v_mov_b32 v44, 1
    v_mov_b32 v45, 135216
    s_lshl_b32 s40, s36, 2
    s_add_u32 s40, s40, 135216
    v_mov_b32 v22, s40
    s_lshl_b32 s40, s35, 12
    s_lshl_b32 s41, s34, 7
    s_add_u32 s40, s40, s41
    s_add_u32 s40, s40, 18219008
    v_mov_b32 v46, s40
    s_lshl_b32 s62, s36, 12
    s_lshl_b32 s55, s34, 17
    s_add_u32 s55, s55, s62
    s_add_u32 s40, s62, 98304
    v_add_u32 v23, s40, v1
    v_lshlrev_b32 v24, 2, v0
    v_add_u32 v24, s40, v24
    s_lshr_b32 s40, s36, 1
    s_xor_b32 s41, s95, s40
    s_lshl_b32 s41, s41, 1
    s_mul_i32 s48, s41, 112
    s_lshl_b32 s45, s94, 3
    s_and_b32 s40, s36, 1
    s_lshl_b32 s40, s40, 2
    s_add_u32 s45, s45, s40
    s_add_u32 s48, s48, s45
    s_lshl_b32 s48, s48, 10
    s_add_u32 s48, s48, 4194304
    s_add_u32 s49, s48, 114688
    s_lshl_b32 s85, s41, 7
    s_add_u32 s85, s85, 18251776
    s_lshl_b32 s40, s35, 2
    s_add_u32 s40, s40, s36
    s_lshl_b32 s46, s40, 16
    s_lshl_b32 s41, s34, 10
    s_add_u32 s46, s46, s41
    s_add_u32 s46, s46, 13893632
    s_add_u32 s47, s46, 32768
    v_mov_b32 v28, -1
    v_mov_b32 v29, -1
    v_mov_b32 v30, -1
    v_mov_b32 v31, -1
    s_mov_b32 s50, 6
    s_mov_b32 s56, 0
    s_mov_b32 s57, 0
    s_mov_b32 s59, 0xff
    s_mov_b32 s51, 0
    v_cmp_eq_u32 vcc, 8, v0
    v_mov_b32 v19, 0
    v_mov_b32 v47, 0
    v_cndmask_b32 v19, v19, 4, vcc
    s_cmp_eq_u32 s94, 14
    s_cselect_b64 vcc, -1, 0
    s_waitcnt vmcnt(8)
    s_barrier
    s_add_u32 s84, s83, 3
    s_and_b32 s84, s84, 7
    s_lshl_b32 s43, s84, 7
    s_mul_i32 s44, s84, 196608
    s_add_u32 s45, s44, 98304
    s_add_u32 m0, s42, 24576
    s_nop 0
    buffer_load_dwordx4 v10, s[8:11], s43 offen lds
    s_add_u32 m0, s42, 65536
    s_nop 0
    buffer_load_dwordx4 v11, s[12:15], s44 offen offset:0 lds
    s_add_u32 m0, s42, 72704
    s_nop 0
    buffer_load_dwordx4 v12, s[12:15], s44 offen offset:1024 lds
    s_add_u32 m0, s42, 79872
    s_nop 0
    buffer_load_dwordx4 v11, s[12:15], s44 offen offset:2048 lds
    s_add_u32 s43, s43, 32768
    s_add_u32 m0, s42, 28672
    s_nop 0
    buffer_load_dwordx4 v10, s[8:11], s43 offen lds
    s_add_u32 m0, s42, 69632
    s_nop 0
    buffer_load_dwordx4 v11, s[12:15], s45 offen offset:0 lds
    s_add_u32 m0, s42, 76800
    s_nop 0
    buffer_load_dwordx4 v12, s[12:15], s45 offen offset:1024 lds
    s_add_u32 m0, s42, 83968
    s_nop 0
    buffer_load_dwordx4 v11, s[12:15], s45 offen offset:2048 lds
    s_waitcnt vmcnt(8)
    s_barrier
    s_add_u32 s84, s83, 4
    s_and_b32 s84, s84, 7
    s_lshl_b32 s43, s84, 7
    s_mul_i32 s44, s84, 196608
    s_add_u32 s45, s44, 98304
    s_add_u32 m0, s42, 32768
    s_nop 0
    buffer_load_dwordx4 v10, s[8:11], s43 offen lds
    s_add_u32 m0, s42, 90112
    s_nop 0
    buffer_load_dwordx4 v11, s[12:15], s44 offen offset:0 lds
    s_add_u32 m0, s42, 97280
    s_nop 0
    buffer_load_dwordx4 v12, s[12:15], s44 offen offset:1024 lds
    s_add_u32 m0, s42, 104448
    s_nop 0
    buffer_load_dwordx4 v11, s[12:15], s44 offen offset:2048 lds
    s_add_u32 s43, s43, 32768
    s_add_u32 m0, s42, 36864
    s_nop 0
    buffer_load_dwordx4 v10, s[8:11], s43 offen lds
    s_add_u32 m0, s42, 94208
    s_nop 0
    buffer_load_dwordx4 v11, s[12:15], s45 offen offset:0 lds
    s_add_u32 m0, s42, 101376
    s_nop 0
    buffer_load_dwordx4 v12, s[12:15], s45 offen offset:1024 lds
    s_add_u32 m0, s42, 108544
    s_nop 0
    buffer_load_dwordx4 v11, s[12:15], s45 offen offset:2048 lds
    s_waitcnt vmcnt(8)
    s_barrier
    s_add_u32 s84, s83, 5
    s_and_b32 s84, s84, 7
    s_lshl_b32 s43, s84, 7
    s_mul_i32 s44, s84, 196608
    s_add_u32 s45, s44, 98304
    s_add_u32 m0, s42, 40960
    s_nop 0
    buffer_load_dwordx4 v10, s[8:11], s43 offen lds
    s_add_u32 m0, s42, 114688
    s_nop 0
    buffer_load_dwordx4 v11, s[12:15], s44 offen offset:0 lds
    s_add_u32 m0, s42, 121856
    s_nop 0
    buffer_load_dwordx4 v12, s[12:15], s44 offen offset:1024 lds
    s_add_u32 m0, s42, 129024
    s_nop 0
    buffer_load_dwordx4 v11, s[12:15], s44 offen offset:2048 lds
    s_add_u32 s43, s43, 32768
    s_add_u32 m0, s42, 45056
    s_nop 0
    buffer_load_dwordx4 v10, s[8:11], s43 offen lds
    s_add_u32 m0, s42, 118784
    s_nop 0
    buffer_load_dwordx4 v11, s[12:15], s45 offen offset:0 lds
    s_add_u32 m0, s42, 125952
    s_nop 0
    buffer_load_dwordx4 v12, s[12:15], s45 offen offset:1024 lds
    s_add_u32 m0, s42, 133120
    s_nop 0
    buffer_load_dwordx4 v11, s[12:15], s45 offen offset:2048 lds
    s_waitcnt vmcnt(8)
    s_barrier
    s_add_u32 s84, s83, 6
    s_and_b32 s84, s84, 7
    s_lshl_b32 s43, s84, 7
    s_mul_i32 s44, s84, 196608
    s_add_u32 s45, s44, 98304
    s_add_u32 m0, s42, 49152
    s_nop 0
    buffer_load_dwordx4 v10, s[8:11], s43 offen lds
    s_add_u32 m0, s42, 139264
    s_nop 0
    buffer_load_dwordx4 v11, s[12:15], s44 offen offset:0 lds
    s_add_u32 m0, s42, 146432
    s_nop 0
    buffer_load_dwordx4 v12, s[12:15], s44 offen offset:1024 lds
    s_add_u32 m0, s42, 153600
    s_nop 0
    buffer_load_dwordx4 v11, s[12:15], s44 offen offset:2048 lds
    s_add_u32 s43, s43, 32768
    s_add_u32 m0, s42, 53248
    s_nop 0
    buffer_load_dwordx4 v10, s[8:11], s43 offen lds
    s_add_u32 m0, s42, 143360
    s_nop 0
    buffer_load_dwordx4 v11, s[12:15], s45 offen offset:0 lds
    s_add_u32 m0, s42, 150528
    s_nop 0
    buffer_load_dwordx4 v12, s[12:15], s45 offen offset:1024 lds
    s_add_u32 m0, s42, 157696
    s_nop 0
    buffer_load_dwordx4 v11, s[12:15], s45 offen offset:2048 lds
    s_waitcnt vmcnt(8)
    s_barrier
    s_add_u32 s84, s83, 7
    s_and_b32 s84, s84, 7
    s_lshl_b32 s43, s84, 7
    s_mul_i32 s44, s84, 196608
    s_add_u32 s45, s44, 98304
    s_add_u32 m0, s42, 57344
    s_nop 0
    buffer_load_dwordx4 v10, s[8:11], s43 offen lds
    s_add_u32 m0, s42, 65536
    s_nop 0
    buffer_load_dwordx4 v11, s[12:15], s44 offen offset:0 lds
    s_add_u32 m0, s42, 72704
    s_nop 0
    buffer_load_dwordx4 v12, s[12:15], s44 offen offset:1024 lds
    s_add_u32 m0, s42, 79872
    s_nop 0
    buffer_load_dwordx4 v11, s[12:15], s44 offen offset:2048 lds
    s_add_u32 s43, s43, 32768
    s_add_u32 m0, s42, 61440
    s_nop 0
    buffer_load_dwordx4 v10, s[8:11], s43 offen lds
    s_add_u32 m0, s42, 69632
    s_nop 0
    buffer_load_dwordx4 v11, s[12:15], s45 offen offset:0 lds
    s_add_u32 m0, s42, 76800
    s_nop 0
    buffer_load_dwordx4 v12, s[12:15], s45 offen offset:1024 lds
    s_add_u32 m0, s42, 83968
    s_nop 0
    buffer_load_dwordx4 v11, s[12:15], s45 offen offset:2048 lds
    s_add_u32 s84, s83, 1
    s_and_b32 s84, s84, 7
    s_lshl_b32 s43, s84, 7
    s_mul_i32 s44, s84, 229376
    s_add_u32 s45, s44, 114688
    s_add_u32 m0, s42, 90112
    s_nop 0
    buffer_load_dwordx4 v13, s[8:11], s43 offen lds
    s_cbranch_vccnz A_GD9
    s_add_u32 m0, s99, 98304
    s_nop 0
    buffer_load_dwordx4 v14, s[20:23], s44 offen offset:0 lds
A_GE9:
    s_add_u32 m0, s42, 106368
    s_nop 0
    buffer_load_dwordx4 v14, s[20:23], s44 offen offset:128 lds
    s_add_u32 s43, s43, 32768
    s_add_u32 m0, s42, 94208
    s_nop 0
    buffer_load_dwordx4 v13, s[8:11], s43 offen lds
    s_add_u32 m0, s99, 102400
    s_nop 0
    buffer_load_dwordx4 v14, s[20:23], s45 offen offset:0 lds
    s_add_u32 m0, s42, 110464
    s_nop 0
    buffer_load_dwordx4 v14, s[20:23], s45 offen offset:128 lds
    s_waitcnt vmcnt(14)
    s_barrier
    s_add_u32 s84, s83, 2
    s_and_b32 s84, s84, 7
    s_lshl_b32 s43, s84, 7
    s_mul_i32 s44, s84, 229376
    s_add_u32 s45, s44, 114688
    s_add_u32 m0, s42, 114688
    s_nop 0
    buffer_load_dwordx4 v13, s[8:11], s43 offen lds
    s_cbranch_vccnz A_GD10
    s_add_u32 m0, s99, 122880
    s_nop 0
    buffer_load_dwordx4 v14, s[20:23], s44 offen offset:0 lds
A_GE10:
    s_add_u32 m0, s42, 130944
    s_nop 0
    buffer_load_dwordx4 v14, s[20:23], s44 offen offset:128 lds
    s_add_u32 s43, s43, 32768
    s_add_u32 m0, s42, 118784
    s_nop 0
    buffer_load_dwordx4 v13, s[8:11], s43 offen lds
    s_add_u32 m0, s99, 126976
    s_nop 0
    buffer_load_dwordx4 v14, s[20:23], s45 offen offset:0 lds
    s_add_u32 m0, s42, 135040
    s_nop 0
    buffer_load_dwordx4 v14, s[20:23], s45 offen offset:128 lds
    s_waitcnt vmcnt(12)
    s_barrier
    s_add_u32 s84, s83, 3
    s_and_b32 s84, s84, 7
    s_lshl_b32 s43, s84, 7
    s_mul_i32 s44, s84, 229376
    s_add_u32 s45, s44, 114688
    s_add_u32 m0, s42, 139264
    s_nop 0
    buffer_load_dwordx4 v13, s[8:11], s43 offen lds
    s_cbranch_vccnz A_GD11
    s_add_u32 m0, s99, 147456
    s_nop 0
    buffer_load_dwordx4 v14, s[20:23], s44 offen offset:0 lds
A_GE11:
    s_add_u32 m0, s42, 155520
    s_nop 0
    buffer_load_dwordx4 v14, s[20:23], s44 offen offset:128 lds
    s_add_u32 s43, s43, 32768
    s_add_u32 m0, s42, 143360
    s_nop 0
    buffer_load_dwordx4 v13, s[8:11], s43 offen lds
    s_add_u32 m0, s99, 151552
    s_nop 0
    buffer_load_dwordx4 v14, s[20:23], s45 offen offset:0 lds
    s_add_u32 m0, s42, 159616
    s_nop 0
    buffer_load_dwordx4 v14, s[20:23], s45 offen offset:128 lds
    s_waitcnt vmcnt(12)
    s_barrier
    s_add_u32 s84, s83, 4
    s_and_b32 s84, s84, 7
    s_lshl_b32 s43, s84, 7
    s_mul_i32 s44, s84, 229376
    s_add_u32 s45, s44, 114688
    s_add_u32 m0, s42, 65536
    s_nop 0
    buffer_load_dwordx4 v13, s[8:11], s43 offen lds
    s_cbranch_vccnz A_GD12
    s_add_u32 m0, s99, 73728
    s_nop 0
    buffer_load_dwordx4 v14, s[20:23], s44 offen offset:0 lds
A_GE12:
    s_add_u32 m0, s42, 81792
    s_nop 0
    buffer_load_dwordx4 v14, s[20:23], s44 offen offset:128 lds
    s_add_u32 s43, s43, 32768
    s_add_u32 m0, s42, 69632
    s_nop 0
    buffer_load_dwordx4 v13, s[8:11], s43 offen lds
    s_add_u32 m0, s99, 77824
    s_nop 0
    buffer_load_dwordx4 v14, s[20:23], s45 offen offset:0 lds
    s_add_u32 m0, s42, 85888
    s_nop 0
    buffer_load_dwordx4 v14, s[20:23], s45 offen offset:128 lds
    s_waitcnt vmcnt(12)
    s_barrier
    s_add_u32 s84, s83, 5
    s_and_b32 s84, s84, 7
    s_lshl_b32 s43, s84, 7
    s_mul_i32 s44, s84, 229376
    s_add_u32 s45, s44, 114688
    s_add_u32 m0, s42, 90112
    s_nop 0
    buffer_load_dwordx4 v13, s[8:11], s43 offen lds
    s_cbranch_vccnz A_GD13
    s_add_u32 m0, s99, 98304
    s_nop 0
    buffer_load_dwordx4 v14, s[20:23], s44 offen offset:0 lds
A_GE13:
    s_add_u32 m0, s42, 106368
    s_nop 0
    buffer_load_dwordx4 v14, s[20:23], s44 offen offset:128 lds
    s_add_u32 s43, s43, 32768
    s_add_u32 m0, s42, 94208
    s_nop 0
    buffer_load_dwordx4 v13, s[8:11], s43 offen lds
    s_add_u32 m0, s99, 102400
    s_nop 0
    buffer_load_dwordx4 v14, s[20:23], s45 offen offset:0 lds
    s_add_u32 m0, s42, 110464
    s_nop 0
    buffer_load_dwordx4 v14, s[20:23], s45 offen offset:128 lds
    s_waitcnt vmcnt(12)
    s_barrier
    s_add_u32 s84, s83, 6
    s_and_b32 s84, s84, 7
    s_lshl_b32 s43, s84, 7
    s_mul_i32 s44, s84, 229376
    s_add_u32 s45, s44, 114688
    s_add_u32 m0, s42, 114688
    s_nop 0
    buffer_load_dwordx4 v13, s[8:11], s43 offen lds
    s_cbranch_vccnz A_GD14
    s_add_u32 m0, s99, 122880
    s_nop 0
    buffer_load_dwordx4 v14, s[20:23], s44 offen offset:0 lds
A_GE14:
    s_add_u32 m0, s42, 130944
    s_nop 0
    buffer_load_dwordx4 v14, s[20:23], s44 offen offset:128 lds
    s_add_u32 s43, s43, 32768
    s_add_u32 m0, s42, 118784
    s_nop 0
    buffer_load_dwordx4 v13, s[8:11], s43 offen lds
    s_add_u32 m0, s99, 126976
    s_nop 0
    buffer_load_dwordx4 v14, s[20:23], s45 offen offset:0 lds
    s_add_u32 m0, s42, 135040
    s_nop 0
    buffer_load_dwordx4 v14, s[20:23], s45 offen offset:128 lds
    s_waitcnt vmcnt(12)
    s_barrier
    s_add_u32 s84, s83, 7
    s_and_b32 s84, s84, 7
    s_lshl_b32 s43, s84, 7
    s_mul_i32 s44, s84, 229376
    s_add_u32 s45, s44, 114688
    s_add_u32 m0, s42, 139264
    s_nop 0
    buffer_load_dwordx4 v13, s[8:11], s43 offen lds
    s_cbranch_vccnz A_GD15
    s_add_u32 m0, s99, 147456
    s_nop 0
    buffer_load_dwordx4 v14, s[20:23], s44 offen offset:0 lds
A_GE15:
    s_add_u32 m0, s42, 155520
    s_nop 0
    buffer_load_dwordx4 v14, s[20:23], s44 offen offset:128 lds
    s_add_u32 s43, s43, 32768
    s_add_u32 m0, s42, 143360
    s_nop 0
    buffer_load_dwordx4 v13, s[8:11], s43 offen lds
    s_add_u32 m0, s99, 151552
    s_nop 0
    buffer_load_dwordx4 v14, s[20:23], s45 offen offset:0 lds
    s_add_u32 m0, s42, 159616
    s_nop 0
    buffer_load_dwordx4 v14, s[20:23], s45 offen offset:128 lds
    buffer_load_dword v20, v47, s[72:75], 0 offen sc1
    s_mov_b64 exec, 0xff
    buffer_load_dword v3, v39, s[16:19], 0 offen sc1
    s_mov_b64 exec, -1
    s_waitcnt vmcnt(14)
    s_barrier
    s_and_b32 s40, s36, 1
    s_lshl_b32 s41, s39, 1
    s_add_u32 s40, s40, s41
    s_lshl_b32 s40, s40, 6
    v_lshrrev_b32 v2, 2, v0
    v_lshlrev_b32 v2, 10, v2
    v_and_b32 v8, 3, v0
    v_lshlrev_b32 v4, 4, v8
    v_add3_u32 v32, v2, v4, s40
    v_lshlrev_b32 v8, 2, v8
    v_add_u32 v8, 135280, v8
    v_lshrrev_b32 v2, 5, v0
    v_bfe_u32 v4, v0, 2, 2
    v_lshl_add_u32 v33, v2, 2, v4
    v_lshlrev_b32 v33, 6, v33
    v_bfe_u32 v4, v0, 4, 1
    v_lshl_add_u32 v33, v4, 5, v33
    v_and_b32 v4, 1, v0
    v_lshl_add_u32 v33, v4, 4, v33
    v_bfe_u32 v4, v0, 1, 1
    v_lshl_add_u32 v33, v4, 3, v33
    s_mul_i32 s40, s36, 3072
    s_add_u32 s40, s40, 147456
    v_add_u32 v33, s40, v33
    v_add_u32 v10, 4096, v1
    v_and_b32 v36, 31, v0
    v_lshlrev_b32 v13, 10, v36
    v_lshl_add_u32 v13, v2, 4, v13
    s_xor_b32 s41, s62, 0x1000
    v_add_u32 v11, s41, v1
    s_xor_b32 s41, s62, 0x2000
    v_add_u32 v12, s41, v1
    s_xor_b32 s41, s62, 0x3000
    v_add_u32 v14, s41, v1
    v_add_u32 v9, s62, v1
    v_mov_b32 v21, 135248
    s_lshl_b32 s40, s35, 12
    v_lshl_add_u32 v2, v0, 7, s40
    v_and_b32 v4, 7, v0
    v_lshlrev_b32 v4, 12, v4
    v_bfe_u32 v5, v0, 3, 2
    v_lshl_add_u32 v4, v5, 10, v4
    s_lshl_b32 s40, s39, 7
    v_add_u32 v4, s40, v4
    v_cmp_gt_u32 vcc, 32, v0
    v_lshlrev_b32 v35, 2, v0
    s_and_b32 s40, s36, 1
    v_cndmask_b32 v34, v4, v2, vcc
    s_lshl_b32 s40, s40, 7
    v_lshl_add_u32 v36, v36, 2, s40
    s_lshl_b32 s40, s36, 8
    s_add_u32 s40, s40, 161792
    v_add_u32 v37, s40, v35
    v_mov_b32 v4, v9
    v_add_u32 v6, 49152, v9
    v_lshlrev_b32 v5, 10, v0
    v_add_u32 v5, 1020, v5
    s_waitcnt vmcnt(8)
    s_barrier
    s_waitcnt vmcnt(0)
    v_readfirstlane_b32 s54, v20
    s_mov_b32 s58, 0
A_EP:
    s_cmp_lg_u32 s54, 0
    s_cbranch_scc1 A_EPD
    buffer_load_dword v20, v47, s[72:75], 0 offen sc1
    s_add_u32 s58, s58, 1
    s_waitcnt vmcnt(0)
    v_readfirstlane_b32 s54, v20
    s_cmp_lt_u32 s58, 65536
    s_cbranch_scc1 A_EP
A_EPD:
    v_cmp_eq_u32 vcc, s54, v3
    s_nop 3
    s_and_b32 s60, vcc_lo, s59
    s_ff1_i32_b32 s40, s60
    s_bitset0_b32 s59, s40
    s_lshl_b32 s41, s40, 14
    s_add_u32 s41, s41, s55
    s_lshl_b32 s61, s56, 14
    s_add_u32 m0, s61, s62
    s_cmp_lg_u32 s60, 0
    s_cselect_b32 s41, s41, s55
    s_addc_u32 s56, s56, 0
    s_bitset0_b32 s60, s40
    buffer_load_dwordx4 v1, s[16:19], s41 offen offset:0 sc1 lds
    buffer_load_dwordx4 v1, s[16:19], s41 offen offset:1024 sc1 lds
    buffer_load_dwordx4 v1, s[16:19], s41 offen offset:2048 sc1 lds
    buffer_load_dwordx4 v1, s[16:19], s41 offen offset:3072 sc1 lds
    s_mov_b64 exec, 0xff
    buffer_load_dword v3, v39, s[16:19], 0 offen sc1
    s_mov_b64 exec, -1
    s_barrier
    s_barrier
    s_setprio 1
    s_mov_b32 s58, 2
A_LD:
    s_waitcnt vmcnt(0)
    s_cmp_eq_u32 s57, s56
    s_cbranch_scc1 A_LD2
    s_lshl_b32 s40, 1, s56
    s_lshl_b32 s41, 1, s57
    s_sub_u32 s40, s40, s41
    s_mov_b32 s41, 0
    s_mov_b64 exec, s[40:41]
    ds_add_u32 v43, v44
    s_mov_b64 exec, -1
    s_mov_b32 s57, s56
A_LD2:
    s_cmp_eq_u32 s57, 8
    s_cbranch_scc1 A_LDD
    s_cmp_eq_u32 s50, 8
    s_cbranch_scc1 A_HO2
    s_cmp_eq_u32 s57, 0
    s_cbranch_scc1 A_HO2
A_HW:
    ds_read_b32 v2, v22
    s_waitcnt lgkmcnt(0)
    v_readfirstlane_b32 s40, v2
    s_cmp_lg_u32 s40, 0
    s_cbranch_scc1 A_HW2
    s_sleep 1
    s_branch A_HW
A_HW2:
    ds_read_b128 v[96:99], v23 offset:0
    ds_read_b128 v[100:103], v23 offset:1024
    ds_read_b128 v[104:107], v23 offset:2048
    ds_read_b128 v[108:111], v23 offset:3072
    ds_read_b128 v[112:115], v23 offset:16384
    ds_read_b128 v[116:119], v23 offset:17408
    ds_read_b128 v[120:123], v23 offset:18432
    ds_read_b128 v[124:127], v23 offset:19456
    ds_read_b32 v2, v24
    s_mov_b32 s50, 8
    s_waitcnt lgkmcnt(0)
A_HO2:
    s_add_u32 s61, s56, s58
    s_min_u32 s61, s61, s50
    v_cmp_eq_u32 vcc, s54, v3
    s_add_u32 s51, s51, 1
    s_cmp_ge_u32 s51, 65536
    s_cselect_b32 s60, -1, 0
    s_nop 0
    s_or_b32 s60, s60, vcc_lo
A_IS1:
    s_cmp_ge_u32 s56, s61
    s_cbranch_scc1 A_ISD1
    s_and_b32 s60, s60, s59
    s_cbranch_scc0 A_ISD1
    s_ff1_i32_b32 s40, s60
    s_bitset0_b32 s59, s40
    s_lshl_b32 s40, s40, 14
    s_add_u32 s40, s40, s55
    s_lshl_b32 s41, s56, 14
    s_add_u32 m0, s41, s62
    s_add_u32 s56, s56, 1
    buffer_load_dwordx4 v1, s[16:19], s40 offen sc1 lds
    buffer_load_dwordx4 v1, s[16:19], s40 offen offset:1024 sc1 lds
    buffer_load_dwordx4 v1, s[16:19], s40 offen offset:2048 sc1 lds
    buffer_load_dwordx4 v1, s[16:19], s40 offen offset:3072 sc1 lds
    s_branch A_IS1
A_ISD1:
    s_mov_b64 exec, 0xff
    buffer_load_dword v3, v39, s[16:19], 0 offen sc1
    s_mov_b64 exec, -1
    s_cmp_eq_u32 s58, 8
    s_cbranch_scc1 A_LD
    s_cmp_lt_u32 s57, 2
    s_cbranch_scc1 A_LD
    buffer_store_dwordx4 v[28:31], v1, s[16:19], s46 offen sc1
    buffer_store_dwordx4 v[28:31], v1, s[16:19], s47 offen sc1
    s_mov_b32 s58, 8
    s_cmp_ge_u32 s94, 14
    s_cbranch_scc1 A_HG
    buffer_store_dwordx4 v[96:99], v1, s[16:19], s48 offen offset:0 sc1
    buffer_store_dwordx4 v[100:103], v1, s[16:19], s48 offen offset:1024 sc1
    buffer_store_dwordx4 v[104:107], v1, s[16:19], s48 offen offset:2048 sc1
    buffer_store_dwordx4 v[108:111], v1, s[16:19], s48 offen offset:3072 sc1
    buffer_store_dwordx4 v[112:115], v1, s[16:19], s49 offen offset:0 sc1
    buffer_store_dwordx4 v[116:119], v1, s[16:19], s49 offen offset:1024 sc1
    buffer_store_dwordx4 v[120:123], v1, s[16:19], s49 offen offset:2048 sc1
    buffer_store_dwordx4 v[124:127], v1, s[16:19], s49 offen offset:3072 sc1
    s_branch A_LD
A_HG:
    s_and_b32 s40, s36, 1
    s_add_u32 s40, s40, s94
    s_cmp_lg_u32 s40, 14
    s_cbranch_scc1 A_LD
    buffer_store_dword v2, v35, s[16:19], s85 offen sc1
    s_branch A_LD
A_LDD:
    s_lshl_b32 s56, s38, 3
    s_add_u32 s56, s56, s35
    s_and_b32 s58, s36, 1
    s_lshl_b32 s40, s39, 1
    s_add_u32 s58, s58, s40
    s_lshr_b32 s57, s36, 1
    s_lshl_b32 s40, s56, 1
    s_add_u32 s57, s57, s40
    s_mul_i32 s59, s36, 3072
    s_add_u32 s59, s59, 147456
    s_min_u32 s40, s57, 55
    s_lshl_b32 s40, s40, 15
    s_mov_b32 m0, s59
    s_add_u32 s41, s40, 16384
    buffer_load_dwordx4 v32, s[24:27], s40 offen lds
    s_add_u32 m0, s59, 1024
    s_lshl_b32 s40, s56, 14
    buffer_load_dwordx4 v32, s[24:27], s41 offen lds
    s_add_u32 m0, s59, 2048
    s_nop 0
    buffer_load_dwordx4 v32, s[28:31], s40 offen lds
    s_mul_i32 s40, s58, 112
    s_lshl_b32 s41, s57, 1
    s_add_u32 s40, s40, s41
    s_lshl_b32 s40, s40, 10
    s_add_u32 s60, s40, 11534336
    s_lshl_b32 s41, s58, 5
    s_add_u32 s41, s41, s56
    s_lshl_b32 s41, s41, 10
    s_add_u32 s61, s41, 13369344
    s_waitcnt vmcnt(0)
    ds_read_b64_tr_b16 v[80:81], v33
    ds_read_b64_tr_b16 v[82:83], v33 offset:1024
    ds_read_b64_tr_b16 v[84:85], v33 offset:512
    ds_read_b64_tr_b16 v[86:87], v33 offset:1536
    ds_read_b64_tr_b16 v[88:89], v33 offset:2048
    ds_read_b64_tr_b16 v[90:91], v33 offset:2560
    s_waitcnt lgkmcnt(0)
    s_cmp_ge_u32 s36, 2
    s_cbranch_scc1 A_NOWO
    buffer_store_dwordx4 v[88:91], v1, s[16:19], s61 offen sc1
A_NOWO:
    s_cmp_ge_u32 s56, 28
    s_cbranch_scc1 A_NOW2
    buffer_store_dwordx4 v[80:83], v1, s[16:19], s60 offen sc1
    buffer_store_dwordx4 v[84:87], v1, s[16:19], s60 offen offset:1024 sc1
A_NOW2:
    s_and_b32 s87, s36, 1
    s_lshr_b32 s88, s36, 1
    s_lshl_b32 s40, s35, 2
    s_add_u32 s86, s40, s38
    s_mul_i32 s45, s86, 229376
    s_mul_i32 s41, s36, 28672
    s_add_u32 s45, s45, s41
    s_add_u32 s45, s45, 4194304
    s_add_u32 s46, s45, 114688
    s_mul_i32 s48, s39, 229376
    s_add_u32 s48, s48, s41
    s_add_u32 s48, s48, 11534336
    s_add_u32 s49, s48, 114688
    s_lshl_b32 s90, s39, 16
    s_lshl_b32 s41, s36, 13
    s_add_u32 s90, s90, s41
    s_add_u32 s90, s90, 13369344
    s_add_u32 s91, s90, 32768
    s_lshl_b32 s92, s86, 16
    s_add_u32 s92, s92, s41
    s_add_u32 s92, s92, 13893632
    s_add_u32 s93, s92, 32768
    s_cmp_eq_u32 s87, 1
    s_cselect_b32 s40, s46, s45
    s_cselect_b32 s46, s45, s46
    s_mov_b32 s45, s40
    s_cselect_b32 s40, s93, s92
    s_cselect_b32 s93, s92, s93
    s_mov_b32 s92, s40
    s_cmp_eq_u32 s88, 1
    s_cselect_b32 s40, s49, s48
    s_cselect_b32 s49, s48, s49
    s_mov_b32 s48, s40
    s_cselect_b32 s40, s91, s90
    s_cselect_b32 s91, s90, s91
    s_mov_b32 s90, s40
    s_lshl_b32 s43, s86, 1
    s_add_u32 s43, s43, s87
    s_lshl_b32 s44, s39, 1
    s_add_u32 s44, s44, s88
    s_lshl_b32 s43, s43, 15
    s_lshl_b32 s44, s44, 6
    s_add_u32 s44, s44, s43
    s_mov_b32 s51, 0
    s_waitcnt vmcnt(0)
    ds_write_b32 v22, v44 offset:64
    s_cmp_lg_u32 s36, 0
    s_cbranch_scc1 A_W1
A_PUB:
    ds_read_b32 v3, v8
    s_waitcnt lgkmcnt(0)
    v_cmp_eq_u32 vcc, 0, v3
    s_nop 3
    s_cmp_lg_u32 vcc_lo, 0
    s_cbranch_scc0 A_PUB2
    s_sleep 2
    s_branch A_PUB
A_PUB2:
    s_mov_b64 exec, 1
    buffer_store_dword v20, v46, s[16:19], 0 offen sc1
    s_mov_b64 exec, -1
    s_mov_b32 s40, 18219008
A_FB:
    buffer_load_dword v3, v34, s[16:19], s40 offen sc1
    s_add_u32 s51, s51, 1
    s_waitcnt vmcnt(0)
    v_cmp_eq_u32 vcc, s54, v3
    s_cmp_ge_u32 s51, 65536
    s_cbranch_scc1 A_FBD
    s_cmp_eq_u64 vcc, exec
    s_cbranch_scc1 A_FBD
    s_sleep 8
    s_branch A_FB
A_FBD:
    ds_write_b32 v21, v44
    s_branch A_W2
A_W1:
    ds_read_b32 v3, v21
    s_waitcnt lgkmcnt(0)
    v_readfirstlane_b32 s40, v3
    s_cmp_lg_u32 s40, 0
    s_cbranch_scc1 A_W2
    s_sleep 4
    s_branch A_W1
A_W2:
    s_lshl_b32 s40, s35, 10
    s_add_u32 s40, s40, 18251776
    s_lshl_b32 s41, s36, 8
    s_add_u32 s41, s41, s40
    buffer_load_dword v3, v35, s[16:19], s41 offen sc1
    s_lshl_b32 s41, s38, 8
    s_add_u32 s41, s41, s40
    buffer_load_dword v7, v36, s[16:19], s41 offen sc1
    buffer_load_dwordx4 v[80:83], v1, s[16:19], s90 offen offset:0 sc1
    buffer_load_dwordx4 v[84:87], v1, s[16:19], s91 offen offset:0 sc1
    buffer_load_dwordx4 v[88:91], v1, s[16:19], s90 offen offset:1024 sc1
    buffer_load_dwordx4 v[92:95], v1, s[16:19], s91 offen offset:1024 sc1
    s_waitcnt vmcnt(4)
    buffer_load_dwordx4 v[96:99], v1, s[16:19], s90 offen offset:2048 sc1
    buffer_load_dwordx4 v[100:103], v1, s[16:19], s91 offen offset:2048 sc1
    buffer_load_dwordx4 v[104:107], v1, s[16:19], s90 offen offset:3072 sc1
    buffer_load_dwordx4 v[108:111], v1, s[16:19], s91 offen offset:3072 sc1
    s_waitcnt vmcnt(4)
    buffer_load_dwordx4 v[112:115], v10, s[16:19], s90 offen offset:0 sc1
    buffer_load_dwordx4 v[116:119], v10, s[16:19], s91 offen offset:0 sc1
    buffer_load_dwordx4 v[120:123], v10, s[16:19], s90 offen offset:1024 sc1
    buffer_load_dwordx4 v[124:127], v10, s[16:19], s91 offen offset:1024 sc1
    s_waitcnt vmcnt(4)
    buffer_load_dwordx4 v[128:131], v10, s[16:19], s90 offen offset:2048 sc1
    buffer_load_dwordx4 v[132:135], v10, s[16:19], s91 offen offset:2048 sc1
    buffer_load_dwordx4 v[136:139], v10, s[16:19], s90 offen offset:3072 sc1
    buffer_load_dwordx4 v[140:143], v10, s[16:19], s91 offen offset:3072 sc1
    s_waitcnt vmcnt(16)
    ds_write_b32 v37, v3
    ds_write_b32 v22, v44 offset:48
    v_add_f32 v7, 1.0, v7
    v_rcp_f32 v7, v7
A_GO:
    ds_read_b32 v3, v8 offset:16
    s_waitcnt lgkmcnt(0)
    v_cmp_gt_u32 vcc, 135188, v3
    s_nop 3
    s_cbranch_vccz A_GOD
    s_sleep 4
    s_branch A_GO
A_GOD:
    s_setprio 1
    s_waitcnt vmcnt(4)
    buffer_load_dwordx4 v[144:147], v1, s[16:19], s48 offen offset:0 sc1
    buffer_load_dwordx4 v[148:151], v1, s[16:19], s45 offen offset:0 sc1
    buffer_load_dwordx4 v[152:155], v1, s[16:19], s46 offen offset:0 sc1
    buffer_load_dwordx4 v[156:159], v1, s[16:19], s49 offen offset:0 sc1
    s_waitcnt vmcnt(4)
    buffer_load_dwordx4 v[160:163], v1, s[16:19], s48 offen offset:1024 sc1
    buffer_load_dwordx4 v[164:167], v1, s[16:19], s45 offen offset:1024 sc1
    buffer_load_dwordx4 v[168:171], v1, s[16:19], s46 offen offset:1024 sc1
    buffer_load_dwordx4 v[172:175], v1, s[16:19], s49 offen offset:1024 sc1
    s_waitcnt vmcnt(4)
    buffer_load_dwordx4 v[176:179], v1, s[16:19], s48 offen offset:2048 sc1
    buffer_load_dwordx4 v[180:183], v1, s[16:19], s45 offen offset:2048 sc1
    buffer_load_dwordx4 v[184:187], v1, s[16:19], s46 offen offset:2048 sc1
    buffer_load_dwordx4 v[188:191], v1, s[16:19], s49 offen offset:2048 sc1
    s_waitcnt vmcnt(4)
    buffer_load_dwordx4 v[192:195], v1, s[16:19], s48 offen offset:3072 sc1
    buffer_load_dwordx4 v[196:199], v1, s[16:19], s45 offen offset:3072 sc1
    buffer_load_dwordx4 v[200:203], v1, s[16:19], s46 offen offset:3072 sc1
    buffer_load_dwordx4 v[204:207], v1, s[16:19], s49 offen offset:3072 sc1
    s_waitcnt vmcnt(4)
    buffer_load_dwordx4 v[208:211], v10, s[16:19], s48 offen offset:0 sc1
    buffer_load_dwordx4 v[212:215], v10, s[16:19], s45 offen offset:0 sc1
    buffer_load_dwordx4 v[216:219], v10, s[16:19], s46 offen offset:0 sc1
    buffer_load_dwordx4 v[220:223], v10, s[16:19], s49 offen offset:0 sc1
    s_waitcnt vmcnt(4)
    buffer_load_dwordx4 v[224:227], v10, s[16:19], s48 offen offset:1024 sc1
    buffer_load_dwordx4 v[228:231], v10, s[16:19], s45 offen offset:1024 sc1
    buffer_load_dwordx4 v[232:235], v10, s[16:19], s46 offen offset:1024 sc1
    buffer_load_dwordx4 v[236:239], v10, s[16:19], s49 offen offset:1024 sc1
    s_waitcnt vmcnt(4)
    buffer_load_dwordx4 v[240:243], v10, s[16:19], s48 offen offset:2048 sc1
    buffer_load_dwordx4 v[244:247], v10, s[16:19], s45 offen offset:2048 sc1
    buffer_load_dwordx4 v[248:251], v10, s[16:19], s46 offen offset:2048 sc1
    buffer_load_dwordx4 v[252:255], v10, s[16:19], s49 offen offset:2048 sc1
    s_waitcnt vmcnt(4)
    s_add_u32 m0, s62, 0
    s_add_u32 s40, s48, 21504
    buffer_load_dwordx4 v1, s[16:19], s40 offen sc1 lds
    s_add_u32 m0, s62, 1024
    s_add_u32 s40, s45, 21504
    buffer_load_dwordx4 v1, s[16:19], s40 offen sc1 lds
    s_add_u32 m0, s62, 2048
    s_add_u32 s40, s46, 21504
    buffer_load_dwordx4 v1, s[16:19], s40 offen sc1 lds
    s_add_u32 m0, s62, 3072
    s_add_u32 s40, s49, 21504
    buffer_load_dwordx4 v1, s[16:19], s40 offen sc1 lds
    s_waitcnt vmcnt(4)
    s_add_u32 m0, s62, 16384
    s_add_u32 s40, s48, 22528
    buffer_load_dwordx4 v1, s[16:19], s40 offen sc1 lds
    s_add_u32 m0, s62, 17408
    s_add_u32 s40, s45, 22528
    buffer_load_dwordx4 v1, s[16:19], s40 offen sc1 lds
    s_add_u32 m0, s62, 18432
    s_add_u32 s40, s46, 22528
    buffer_load_dwordx4 v1, s[16:19], s40 offen sc1 lds
    s_add_u32 m0, s62, 19456
    s_add_u32 s40, s49, 22528
    buffer_load_dwordx4 v1, s[16:19], s40 offen sc1 lds
    s_waitcnt vmcnt(4)
    s_add_u32 m0, s62, 32768
    s_add_u32 s40, s48, 23552
    buffer_load_dwordx4 v1, s[16:19], s40 offen sc1 lds
    s_add_u32 m0, s62, 33792
    s_add_u32 s40, s45, 23552
    buffer_load_dwordx4 v1, s[16:19], s40 offen sc1 lds
    s_add_u32 m0, s62, 34816
    s_add_u32 s40, s46, 23552
    buffer_load_dwordx4 v1, s[16:19], s40 offen sc1 lds
    s_add_u32 m0, s62, 35840
    s_add_u32 s40, s49, 23552
    buffer_load_dwordx4 v1, s[16:19], s40 offen sc1 lds
    s_waitcnt vmcnt(4)
    s_add_u32 m0, s62, 49152
    s_add_u32 s40, s48, 24576
    buffer_load_dwordx4 v1, s[16:19], s40 offen sc1 lds
    s_add_u32 m0, s62, 50176
    s_add_u32 s40, s45, 24576
    buffer_load_dwordx4 v1, s[16:19], s40 offen sc1 lds
    s_add_u32 m0, s62, 51200
    s_add_u32 s40, s46, 24576
    buffer_load_dwordx4 v1, s[16:19], s40 offen sc1 lds
    s_add_u32 m0, s62, 52224
    s_add_u32 s40, s49, 24576
    buffer_load_dwordx4 v1, s[16:19], s40 offen sc1 lds
    s_mov_b32 s51, 0
    s_mov_b32 s47, 0xff
    s_waitcnt vmcnt(4)
    s_waitcnt vmcnt(0)
A_GP0:
    ds_read_b32 v3, v8 offset:16
    s_waitcnt lgkmcnt(0)
    v_cmp_gt_u32 vcc, 135192, v3
    s_nop 3
    s_cbranch_vccz A_GP0D
    s_sleep 2
    s_branch A_GP0
A_GP0D:
    s_add_u32 m0, s62, 65536
    s_add_u32 s40, s48, 25600
    buffer_load_dwordx4 v1, s[16:19], s40 offen sc1 lds
    s_add_u32 m0, s62, 66560
    s_add_u32 s40, s45, 25600
    buffer_load_dwordx4 v1, s[16:19], s40 offen sc1 lds
    s_add_u32 m0, s62, 67584
    s_add_u32 s40, s46, 25600
    buffer_load_dwordx4 v1, s[16:19], s40 offen sc1 lds
    s_add_u32 m0, s62, 68608
    s_add_u32 s40, s49, 25600
    buffer_load_dwordx4 v1, s[16:19], s40 offen sc1 lds
    v_mfma_f32_32x32x16_bf16 v[16:31], v[144:147], v[148:151], 0
    v_mfma_f32_32x32x16_bf16 v[32:47], v[144:147], v[152:155], 0
    v_mfma_f32_32x32x16_bf16 v[48:63], v[156:159], v[148:151], 0
    v_mfma_f32_32x32x16_bf16 v[64:79], v[156:159], v[152:155], 0
    buffer_load_dwordx4 v[144:147], v10, s[16:19], s48 offen offset:3072 sc1
    buffer_load_dwordx4 v[148:151], v10, s[16:19], s45 offen offset:3072 sc1
    buffer_load_dwordx4 v[152:155], v10, s[16:19], s46 offen offset:3072 sc1
    buffer_load_dwordx4 v[156:159], v10, s[16:19], s49 offen offset:3072 sc1
    v_mfma_f32_32x32x16_bf16 v[16:31], v[160:163], v[164:167], v[16:31]
    v_mfma_f32_32x32x16_bf16 v[32:47], v[160:163], v[168:171], v[32:47]
    v_mfma_f32_32x32x16_bf16 v[48:63], v[172:175], v[164:167], v[48:63]
    v_mfma_f32_32x32x16_bf16 v[64:79], v[172:175], v[168:171], v[64:79]
    s_add_u32 s45, s45, 8192
    s_add_u32 s46, s46, 8192
    s_add_u32 s48, s48, 8192
    s_add_u32 s49, s49, 8192
    s_waitcnt vmcnt(4)
    buffer_load_dwordx4 v[160:163], v1, s[16:19], s48 offen offset:0 sc1
    buffer_load_dwordx4 v[164:167], v1, s[16:19], s45 offen offset:0 sc1
    buffer_load_dwordx4 v[168:171], v1, s[16:19], s46 offen offset:0 sc1
    buffer_load_dwordx4 v[172:175], v1, s[16:19], s49 offen offset:0 sc1
    v_mfma_f32_32x32x16_bf16 v[16:31], v[176:179], v[180:183], v[16:31]
    v_mfma_f32_32x32x16_bf16 v[32:47], v[176:179], v[184:187], v[32:47]
    v_mfma_f32_32x32x16_bf16 v[48:63], v[188:191], v[180:183], v[48:63]
    v_mfma_f32_32x32x16_bf16 v[64:79], v[188:191], v[184:187], v[64:79]
    s_waitcnt vmcnt(4)
    buffer_load_dwordx4 v[176:179], v1, s[16:19], s48 offen offset:1024 sc1
    buffer_load_dwordx4 v[180:183], v1, s[16:19], s45 offen offset:1024 sc1
    buffer_load_dwordx4 v[184:187], v1, s[16:19], s46 offen offset:1024 sc1
    buffer_load_dwordx4 v[188:191], v1, s[16:19], s49 offen offset:1024 sc1
    v_mfma_f32_32x32x16_bf16 v[16:31], v[192:195], v[196:199], v[16:31]
    v_mfma_f32_32x32x16_bf16 v[32:47], v[192:195], v[200:203], v[32:47]
    v_mfma_f32_32x32x16_bf16 v[48:63], v[204:207], v[196:199], v[48:63]
    v_mfma_f32_32x32x16_bf16 v[64:79], v[204:207], v[200:203], v[64:79]
    s_waitcnt vmcnt(4)
    buffer_load_dwordx4 v[192:195], v1, s[16:19], s48 offen offset:2048 sc1
    buffer_load_dwordx4 v[196:199], v1, s[16:19], s45 offen offset:2048 sc1
    buffer_load_dwordx4 v[200:203], v1, s[16:19], s46 offen offset:2048 sc1
    buffer_load_dwordx4 v[204:207], v1, s[16:19], s49 offen offset:2048 sc1
A_GP4:
    ds_read_b32 v3, v8 offset:16
    s_waitcnt lgkmcnt(0)
    v_cmp_gt_u32 vcc, 135196, v3
    s_nop 3
    s_cbranch_vccz A_GP4D
    s_sleep 2
    s_branch A_GP4
A_GP4D:
    s_waitcnt vmcnt(4)
    s_add_u32 m0, s62, 81920
    s_add_u32 s40, s48, 18432
    buffer_load_dwordx4 v1, s[16:19], s40 offen sc1 lds
    s_add_u32 m0, s62, 82944
    s_add_u32 s40, s45, 18432
    buffer_load_dwordx4 v1, s[16:19], s40 offen sc1 lds
    s_add_u32 m0, s62, 83968
    s_add_u32 s40, s46, 18432
    buffer_load_dwordx4 v1, s[16:19], s40 offen sc1 lds
    s_add_u32 m0, s62, 84992
    s_add_u32 s40, s49, 18432
    buffer_load_dwordx4 v1, s[16:19], s40 offen sc1 lds
    v_mfma_f32_32x32x16_bf16 v[16:31], v[208:211], v[212:215], v[16:31]
    v_mfma_f32_32x32x16_bf16 v[32:47], v[208:211], v[216:219], v[32:47]
    v_mfma_f32_32x32x16_bf16 v[48:63], v[220:223], v[212:215], v[48:63]
    v_mfma_f32_32x32x16_bf16 v[64:79], v[220:223], v[216:219], v[64:79]
    s_waitcnt vmcnt(4)
    buffer_load_dwordx4 v[208:211], v1, s[16:19], s48 offen offset:3072 sc1
    buffer_load_dwordx4 v[212:215], v1, s[16:19], s45 offen offset:3072 sc1
    buffer_load_dwordx4 v[216:219], v1, s[16:19], s46 offen offset:3072 sc1
    buffer_load_dwordx4 v[220:223], v1, s[16:19], s49 offen offset:3072 sc1
    v_mfma_f32_32x32x16_bf16 v[16:31], v[224:227], v[228:231], v[16:31]
    v_mfma_f32_32x32x16_bf16 v[32:47], v[224:227], v[232:235], v[32:47]
    v_mfma_f32_32x32x16_bf16 v[48:63], v[236:239], v[228:231], v[48:63]
    v_mfma_f32_32x32x16_bf16 v[64:79], v[236:239], v[232:235], v[64:79]
    s_waitcnt vmcnt(4)
    buffer_load_dwordx4 v[224:227], v10, s[16:19], s48 offen offset:0 sc1
    buffer_load_dwordx4 v[228:231], v10, s[16:19], s45 offen offset:0 sc1
    buffer_load_dwordx4 v[232:235], v10, s[16:19], s46 offen offset:0 sc1
    buffer_load_dwordx4 v[236:239], v10, s[16:19], s49 offen offset:0 sc1
    v_mfma_f32_32x32x16_bf16 v[16:31], v[240:243], v[244:247], v[16:31]
    v_mfma_f32_32x32x16_bf16 v[32:47], v[240:243], v[248:251], v[32:47]
    v_mfma_f32_32x32x16_bf16 v[48:63], v[252:255], v[244:247], v[48:63]
    v_mfma_f32_32x32x16_bf16 v[64:79], v[252:255], v[248:251], v[64:79]
    s_waitcnt vmcnt(4)
    buffer_load_dwordx4 v[240:243], v10, s[16:19], s48 offen offset:1024 sc1
    buffer_load_dwordx4 v[244:247], v10, s[16:19], s45 offen offset:1024 sc1
    buffer_load_dwordx4 v[248:251], v10, s[16:19], s46 offen offset:1024 sc1
    buffer_load_dwordx4 v[252:255], v10, s[16:19], s49 offen offset:1024 sc1
    v_mfma_f32_32x32x16_bf16 v[16:31], v[144:147], v[148:151], v[16:31]
    v_mfma_f32_32x32x16_bf16 v[32:47], v[144:147], v[152:155], v[32:47]
    v_mfma_f32_32x32x16_bf16 v[48:63], v[156:159], v[148:151], v[48:63]
    v_mfma_f32_32x32x16_bf16 v[64:79], v[156:159], v[152:155], v[64:79]
    s_waitcnt vmcnt(4)
    buffer_load_dwordx4 v[144:147], v10, s[16:19], s48 offen offset:2048 sc1
    buffer_load_dwordx4 v[148:151], v10, s[16:19], s45 offen offset:2048 sc1
    buffer_load_dwordx4 v[152:155], v10, s[16:19], s46 offen offset:2048 sc1
    buffer_load_dwordx4 v[156:159], v10, s[16:19], s49 offen offset:2048 sc1
    v_mfma_f32_32x32x16_bf16 v[16:31], v[160:163], v[164:167], v[16:31]
    v_mfma_f32_32x32x16_bf16 v[32:47], v[160:163], v[168:171], v[32:47]
    v_mfma_f32_32x32x16_bf16 v[48:63], v[172:175], v[164:167], v[48:63]
    v_mfma_f32_32x32x16_bf16 v[64:79], v[172:175], v[168:171], v[64:79]
    s_waitcnt vmcnt(4)
    buffer_load_dwordx4 v[160:163], v10, s[16:19], s48 offen offset:3072 sc1
    buffer_load_dwordx4 v[164:167], v10, s[16:19], s45 offen offset:3072 sc1
    buffer_load_dwordx4 v[168:171], v10, s[16:19], s46 offen offset:3072 sc1
    buffer_load_dwordx4 v[172:175], v10, s[16:19], s49 offen offset:3072 sc1
A_GP9:
    ds_read_b32 v3, v8 offset:16
    s_waitcnt lgkmcnt(0)
    v_cmp_gt_u32 vcc, 135200, v3
    s_nop 3
    s_cbranch_vccz A_GP9D
    s_sleep 2
    s_branch A_GP9
A_GP9D:
    s_waitcnt vmcnt(4)
    s_add_u32 m0, s62, 98304
    s_add_u32 s40, s48, 19456
    buffer_load_dwordx4 v1, s[16:19], s40 offen sc1 lds
    s_add_u32 m0, s62, 99328
    s_add_u32 s40, s45, 19456
    buffer_load_dwordx4 v1, s[16:19], s40 offen sc1 lds
    s_add_u32 m0, s62, 100352
    s_add_u32 s40, s46, 19456
    buffer_load_dwordx4 v1, s[16:19], s40 offen sc1 lds
    s_add_u32 m0, s62, 101376
    s_add_u32 s40, s49, 19456
    buffer_load_dwordx4 v1, s[16:19], s40 offen sc1 lds
    v_mfma_f32_32x32x16_bf16 v[16:31], v[176:179], v[180:183], v[16:31]
    v_mfma_f32_32x32x16_bf16 v[32:47], v[176:179], v[184:187], v[32:47]
    v_mfma_f32_32x32x16_bf16 v[48:63], v[188:191], v[180:183], v[48:63]
    v_mfma_f32_32x32x16_bf16 v[64:79], v[188:191], v[184:187], v[64:79]
    s_add_u32 s45, s45, 8192
    s_add_u32 s46, s46, 8192
    s_add_u32 s48, s48, 8192
    s_add_u32 s49, s49, 8192
    s_waitcnt vmcnt(4)
    buffer_load_dwordx4 v[176:179], v1, s[16:19], s48 offen offset:0 sc1
    buffer_load_dwordx4 v[180:183], v1, s[16:19], s45 offen offset:0 sc1
    buffer_load_dwordx4 v[184:187], v1, s[16:19], s46 offen offset:0 sc1
    buffer_load_dwordx4 v[188:191], v1, s[16:19], s49 offen offset:0 sc1
    v_mfma_f32_32x32x16_bf16 v[16:31], v[192:195], v[196:199], v[16:31]
    v_mfma_f32_32x32x16_bf16 v[32:47], v[192:195], v[200:203], v[32:47]
    v_mfma_f32_32x32x16_bf16 v[48:63], v[204:207], v[196:199], v[48:63]
    v_mfma_f32_32x32x16_bf16 v[64:79], v[204:207], v[200:203], v[64:79]
    s_waitcnt vmcnt(4)
    buffer_load_dwordx4 v[192:195], v1, s[16:19], s48 offen offset:1024 sc1
    buffer_load_dwordx4 v[196:199], v1, s[16:19], s45 offen offset:1024 sc1
    buffer_load_dwordx4 v[200:203], v1, s[16:19], s46 offen offset:1024 sc1
    buffer_load_dwordx4 v[204:207], v1, s[16:19], s49 offen offset:1024 sc1
    v_mfma_f32_32x32x16_bf16 v[16:31], v[208:211], v[212:215], v[16:31]
    v_mfma_f32_32x32x16_bf16 v[32:47], v[208:211], v[216:219], v[32:47]
    v_mfma_f32_32x32x16_bf16 v[48:63], v[220:223], v[212:215], v[48:63]
    v_mfma_f32_32x32x16_bf16 v[64:79], v[220:223], v[216:219], v[64:79]
    s_waitcnt vmcnt(4)
    buffer_load_dwordx4 v[208:211], v1, s[16:19], s48 offen offset:2048 sc1
    buffer_load_dwordx4 v[212:215], v1, s[16:19], s45 offen offset:2048 sc1
    buffer_load_dwordx4 v[216:219], v1, s[16:19], s46 offen offset:2048 sc1
    buffer_load_dwordx4 v[220:223], v1, s[16:19], s49 offen offset:2048 sc1
    v_mfma_f32_32x32x16_bf16 v[16:31], v[224:227], v[228:231], v[16:31]
    v_mfma_f32_32x32x16_bf16 v[32:47], v[224:227], v[232:235], v[32:47]
    v_mfma_f32_32x32x16_bf16 v[48:63], v[236:239], v[228:231], v[48:63]
    v_mfma_f32_32x32x16_bf16 v[64:79], v[236:239], v[232:235], v[64:79]
    s_waitcnt vmcnt(4)
    buffer_load_dwordx4 v[224:227], v1, s[16:19], s48 offen offset:3072 sc1
    buffer_load_dwordx4 v[228:231], v1, s[16:19], s45 offen offset:3072 sc1
    buffer_load_dwordx4 v[232:235], v1, s[16:19], s46 offen offset:3072 sc1
    buffer_load_dwordx4 v[236:239], v1, s[16:19], s49 offen offset:3072 sc1
    v_mfma_f32_32x32x16_bf16 v[16:31], v[240:243], v[244:247], v[16:31]
    v_mfma_f32_32x32x16_bf16 v[32:47], v[240:243], v[248:251], v[32:47]
    v_mfma_f32_32x32x16_bf16 v[48:63], v[252:255], v[244:247], v[48:63]
    v_mfma_f32_32x32x16_bf16 v[64:79], v[252:255], v[248:251], v[64:79]
    s_waitcnt vmcnt(4)
    buffer_load_dwordx4 v[240:243], v10, s[16:19], s48 offen offset:0 sc1
    buffer_load_dwordx4 v[244:247], v10, s[16:19], s45 offen offset:0 sc1
    buffer_load_dwordx4 v[248:251], v10, s[16:19], s46 offen offset:0 sc1
    buffer_load_dwordx4 v[252:255], v10, s[16:19], s49 offen offset:0 sc1
A_GP14:
    ds_read_b32 v3, v8 offset:16
    s_waitcnt lgkmcnt(0)
    v_cmp_gt_u32 vcc, 135204, v3
    s_nop 3
    s_bitcmp1_b32 vcc_lo, s36
    s_cbranch_scc0 A_GP14D
    s_sleep 2
    s_branch A_GP14
A_GP14D:
    v_mfma_f32_32x32x16_bf16 v[16:31], v[144:147], v[148:151], v[16:31]
    v_mfma_f32_32x32x16_bf16 v[32:47], v[144:147], v[152:155], v[32:47]
    v_mfma_f32_32x32x16_bf16 v[48:63], v[156:159], v[148:151], v[48:63]
    v_mfma_f32_32x32x16_bf16 v[64:79], v[156:159], v[152:155], v[64:79]
    v_mfma_f32_32x32x16_bf16 v[16:31], v[160:163], v[164:167], v[16:31]
    v_mfma_f32_32x32x16_bf16 v[32:47], v[160:163], v[168:171], v[32:47]
    v_mfma_f32_32x32x16_bf16 v[48:63], v[172:175], v[164:167], v[48:63]
    v_mfma_f32_32x32x16_bf16 v[64:79], v[172:175], v[168:171], v[64:79]
    v_mfma_f32_32x32x16_bf16 v[16:31], v[176:179], v[180:183], v[16:31]
    v_mfma_f32_32x32x16_bf16 v[32:47], v[176:179], v[184:187], v[32:47]
    v_mfma_f32_32x32x16_bf16 v[48:63], v[188:191], v[180:183], v[48:63]
    v_mfma_f32_32x32x16_bf16 v[64:79], v[188:191], v[184:187], v[64:79]
    v_mfma_f32_32x32x16_bf16 v[16:31], v[192:195], v[196:199], v[16:31]
    v_mfma_f32_32x32x16_bf16 v[32:47], v[192:195], v[200:203], v[32:47]
    v_mfma_f32_32x32x16_bf16 v[48:63], v[204:207], v[196:199], v[48:63]
    v_mfma_f32_32x32x16_bf16 v[64:79], v[204:207], v[200:203], v[64:79]
    v_mfma_f32_32x32x16_bf16 v[16:31], v[208:211], v[212:215], v[16:31]
    v_mfma_f32_32x32x16_bf16 v[32:47], v[208:211], v[216:219], v[32:47]
    v_mfma_f32_32x32x16_bf16 v[48:63], v[220:223], v[212:215], v[48:63]
    v_mfma_f32_32x32x16_bf16 v[64:79], v[220:223], v[216:219], v[64:79]
    ds_read_b128 v[208:211], v4 offset:0
    ds_read_b128 v[212:215], v4 offset:1024
    ds_read_b128 v[216:219], v4 offset:2048
    ds_read_b128 v[220:223], v4 offset:3072
    s_waitcnt vmcnt(4)
    v_mfma_f32_32x32x16_bf16 v[16:31], v[224:227], v[228:231], v[16:31]
    v_mfma_f32_32x32x16_bf16 v[32:47], v[224:227], v[232:235], v[32:47]
    v_mfma_f32_32x32x16_bf16 v[48:63], v[236:239], v[228:231], v[48:63]
    v_mfma_f32_32x32x16_bf16 v[64:79], v[236:239], v[232:235], v[64:79]
    ds_read_b128 v[224:227], v4 offset:16384
    ds_read_b128 v[228:231], v4 offset:17408
    ds_read_b128 v[232:235], v4 offset:18432
    ds_read_b128 v[236:239], v4 offset:19456
    s_waitcnt vmcnt(0)
    v_mfma_f32_32x32x16_bf16 v[16:31], v[240:243], v[244:247], v[16:31]
    v_mfma_f32_32x32x16_bf16 v[32:47], v[240:243], v[248:251], v[32:47]
    v_mfma_f32_32x32x16_bf16 v[48:63], v[252:255], v[244:247], v[48:63]
    v_mfma_f32_32x32x16_bf16 v[64:79], v[252:255], v[248:251], v[64:79]
    ds_read_b128 v[240:243], v4 offset:32768
    ds_read_b128 v[244:247], v4 offset:33792
    ds_read_b128 v[248:251], v4 offset:34816
    ds_read_b128 v[252:255], v4 offset:35840
    buffer_load_dwordx4 v[144:147], v1, s[16:19], s92 offen offset:0 sc1
    buffer_load_dwordx4 v[148:151], v1, s[16:19], s93 offen offset:0 sc1
    buffer_load_dwordx4 v[152:155], v1, s[16:19], s92 offen offset:1024 sc1
    buffer_load_dwordx4 v[156:159], v1, s[16:19], s93 offen offset:1024 sc1
    buffer_load_dwordx4 v[160:163], v1, s[16:19], s92 offen offset:2048 sc1
    buffer_load_dwordx4 v[164:167], v1, s[16:19], s93 offen offset:2048 sc1
    buffer_load_dwordx4 v[168:171], v1, s[16:19], s92 offen offset:3072 sc1
    buffer_load_dwordx4 v[172:175], v1, s[16:19], s93 offen offset:3072 sc1
    buffer_load_dwordx4 v[176:179], v10, s[16:19], s92 offen offset:0 sc1
    buffer_load_dwordx4 v[180:183], v10, s[16:19], s93 offen offset:0 sc1
    buffer_load_dwordx4 v[184:187], v10, s[16:19], s92 offen offset:1024 sc1
    buffer_load_dwordx4 v[188:191], v10, s[16:19], s93 offen offset:1024 sc1
    buffer_load_dwordx4 v[192:195], v10, s[16:19], s92 offen offset:2048 sc1
    buffer_load_dwordx4 v[196:199], v10, s[16:19], s93 offen offset:2048 sc1
    buffer_load_dwordx4 v[200:203], v10, s[16:19], s92 offen offset:3072 sc1
    buffer_load_dwordx4 v[204:207], v10, s[16:19], s93 offen offset:3072 sc1
    s_waitcnt lgkmcnt(8)
    v_mfma_f32_32x32x16_bf16 v[16:31], v[208:211], v[212:215], v[16:31]
    v_mfma_f32_32x32x16_bf16 v[32:47], v[208:211], v[216:219], v[32:47]
    v_mfma_f32_32x32x16_bf16 v[48:63], v[220:223], v[212:215], v[48:63]
    v_mfma_f32_32x32x16_bf16 v[64:79], v[220:223], v[216:219], v[64:79]
    ds_read_b128 v[208:211], v6 offset:0
    ds_read_b128 v[212:215], v6 offset:1024
    ds_read_b128 v[216:219], v6 offset:2048
    ds_read_b128 v[220:223], v6 offset:3072
    s_waitcnt lgkmcnt(8)
    v_mfma_f32_32x32x16_bf16 v[16:31], v[224:227], v[228:231], v[16:31]
    v_mfma_f32_32x32x16_bf16 v[32:47], v[224:227], v[232:235], v[32:47]
    v_mfma_f32_32x32x16_bf16 v[48:63], v[236:239], v[228:231], v[48:63]
    v_mfma_f32_32x32x16_bf16 v[64:79], v[236:239], v[232:235], v[64:79]
    ds_read_b128 v[224:227], v6 offset:16384
    ds_read_b128 v[228:231], v6 offset:17408
    ds_read_b128 v[232:235], v6 offset:18432
    ds_read_b128 v[236:239], v6 offset:19456
    s_waitcnt lgkmcnt(8)
    v_mfma_f32_32x32x16_bf16 v[16:31], v[240:243], v[244:247], v[16:31]
    v_mfma_f32_32x32x16_bf16 v[32:47], v[240:243], v[248:251], v[32:47]
    v_mfma_f32_32x32x16_bf16 v[48:63], v[252:255], v[244:247], v[48:63]
    v_mfma_f32_32x32x16_bf16 v[64:79], v[252:255], v[248:251], v[64:79]
    ds_read_b128 v[240:243], v6 offset:32768
    ds_read_b128 v[244:247], v6 offset:33792
    ds_read_b128 v[248:251], v6 offset:34816
    ds_read_b128 v[252:255], v6 offset:35840
    s_waitcnt lgkmcnt(8)
    v_mfma_f32_32x32x16_bf16 v[16:31], v[208:211], v[212:215], v[16:31]
    v_mfma_f32_32x32x16_bf16 v[32:47], v[208:211], v[216:219], v[32:47]
    v_mfma_f32_32x32x16_bf16 v[48:63], v[220:223], v[212:215], v[48:63]
    v_mfma_f32_32x32x16_bf16 v[64:79], v[220:223], v[216:219], v[64:79]
    ds_read_b128 v[208:211], v6 offset:49152
    ds_read_b128 v[212:215], v6 offset:50176
    ds_read_b128 v[216:219], v6 offset:51200
    ds_read_b128 v[220:223], v6 offset:52224
    s_waitcnt lgkmcnt(8)
    v_mfma_f32_32x32x16_bf16 v[16:31], v[224:227], v[228:231], v[16:31]
    v_mfma_f32_32x32x16_bf16 v[32:47], v[224:227], v[232:235], v[32:47]
    v_mfma_f32_32x32x16_bf16 v[48:63], v[236:239], v[228:231], v[48:63]
    v_mfma_f32_32x32x16_bf16 v[64:79], v[236:239], v[232:235], v[64:79]
    s_waitcnt lgkmcnt(4)
    v_mfma_f32_32x32x16_bf16 v[16:31], v[240:243], v[244:247], v[16:31]
    v_mfma_f32_32x32x16_bf16 v[32:47], v[240:243], v[248:251], v[32:47]
    v_mfma_f32_32x32x16_bf16 v[48:63], v[252:255], v[244:247], v[48:63]
    v_mfma_f32_32x32x16_bf16 v[64:79], v[252:255], v[248:251], v[64:79]
    s_waitcnt lgkmcnt(0)
    v_mfma_f32_32x32x16_bf16 v[16:31], v[208:211], v[212:215], v[16:31]
    v_mfma_f32_32x32x16_bf16 v[32:47], v[208:211], v[216:219], v[32:47]
    v_mfma_f32_32x32x16_bf16 v[48:63], v[220:223], v[212:215], v[48:63]
    v_mfma_f32_32x32x16_bf16 v[64:79], v[220:223], v[216:219], v[64:79]
    s_setprio 3
    s_waitcnt vmcnt(12)
    v_max3_u32 v2, v144, v145, v146
    v_max3_u32 v3, v147, v148, v149
    v_max3_u32 v2, v2, v150, v151
    v_max3_u32 v2, v2, v3, 1
    v_cmp_eq_u32 vcc, -1, v2
    s_nop 1
    s_cbranch_vccnz A_O10
    s_bitset0_b32 s47, 0
    v_mfma_f32_32x32x16_bf16 v[16:31], v[80:83], v[144:147], v[16:31]
    v_mfma_f32_32x32x16_bf16 v[32:47], v[80:83], v[148:151], v[32:47]
    v_mfma_f32_32x32x16_bf16 v[48:63], v[84:87], v[144:147], v[48:63]
    v_mfma_f32_32x32x16_bf16 v[64:79], v[84:87], v[148:151], v[64:79]
A_O10:
    v_max3_u32 v2, v152, v153, v154
    v_max3_u32 v3, v155, v156, v157
    v_max3_u32 v2, v2, v158, v159
    v_max3_u32 v2, v2, v3, 1
    v_cmp_eq_u32 vcc, -1, v2
    s_nop 1
    s_cbranch_vccnz A_O11
    s_bitset0_b32 s47, 1
    v_mfma_f32_32x32x16_bf16 v[16:31], v[88:91], v[152:155], v[16:31]
    v_mfma_f32_32x32x16_bf16 v[32:47], v[88:91], v[156:159], v[32:47]
    v_mfma_f32_32x32x16_bf16 v[48:63], v[92:95], v[152:155], v[48:63]
    v_mfma_f32_32x32x16_bf16 v[64:79], v[92:95], v[156:159], v[64:79]
A_O11:
    s_waitcnt vmcnt(8)
    v_max3_u32 v2, v160, v161, v162
    v_max3_u32 v3, v163, v164, v165
    v_max3_u32 v2, v2, v166, v167
    v_max3_u32 v2, v2, v3, 1
    v_cmp_eq_u32 vcc, -1, v2
    s_nop 1
    s_cbranch_vccnz A_O12
    s_bitset0_b32 s47, 2
    v_mfma_f32_32x32x16_bf16 v[16:31], v[96:99], v[160:163], v[16:31]
    v_mfma_f32_32x32x16_bf16 v[32:47], v[96:99], v[164:167], v[32:47]
    v_mfma_f32_32x32x16_bf16 v[48:63], v[100:103], v[160:163], v[48:63]
    v_mfma_f32_32x32x16_bf16 v[64:79], v[100:103], v[164:167], v[64:79]
A_O12:
    v_max3_u32 v2, v168, v169, v170
    v_max3_u32 v3, v171, v172, v173
    v_max3_u32 v2, v2, v174, v175
    v_max3_u32 v2, v2, v3, 1
    v_cmp_eq_u32 vcc, -1, v2
    s_nop 1
    s_cbranch_vccnz A_O13
    s_bitset0_b32 s47, 3
    v_mfma_f32_32x32x16_bf16 v[16:31], v[104:107], v[168:171], v[16:31]
    v_mfma_f32_32x32x16_bf16 v[32:47], v[104:107], v[172:175], v[32:47]
    v_mfma_f32_32x32x16_bf16 v[48:63], v[108:111], v[168:171], v[48:63]
    v_mfma_f32_32x32x16_bf16 v[64:79], v[108:111], v[172:175], v[64:79]
A_O13:
    s_waitcnt vmcnt(4)
    v_max3_u32 v2, v176, v177, v178
    v_max3_u32 v3, v179, v180, v181
    v_max3_u32 v2, v2, v182, v183
    v_max3_u32 v2, v2, v3, 1
    v_cmp_eq_u32 vcc, -1, v2
    s_nop 1
    s_cbranch_vccnz A_O14
    s_bitset0_b32 s47, 4
    v_mfma_f32_32x32x16_bf16 v[16:31], v[112:115], v[176:179], v[16:31]
    v_mfma_f32_32x32x16_bf16 v[32:47], v[112:115], v[180:183], v[32:47]
    v_mfma_f32_32x32x16_bf16 v[48:63], v[116:119], v[176:179], v[48:63]
    v_mfma_f32_32x32x16_bf16 v[64:79], v[116:119], v[180:183], v[64:79]
A_O14:
    v_max3_u32 v2, v184, v185, v186
    v_max3_u32 v3, v187, v188, v189
    v_max3_u32 v2, v2, v190, v191
    v_max3_u32 v2, v2, v3, 1
    v_cmp_eq_u32 vcc, -1, v2
    s_nop 1
    s_cbranch_vccnz A_O15
    s_bitset0_b32 s47, 5
    v_mfma_f32_32x32x16_bf16 v[16:31], v[120:123], v[184:187], v[16:31]
    v_mfma_f32_32x32x16_bf16 v[32:47], v[120:123], v[188:191], v[32:47]
    v_mfma_f32_32x32x16_bf16 v[48:63], v[124:127], v[184:187], v[48:63]
    v_mfma_f32_32x32x16_bf16 v[64:79], v[124:127], v[188:191], v[64:79]
A_O15:
    s_waitcnt vmcnt(0)
    v_max3_u32 v2, v192, v193, v194
    v_max3_u32 v3, v195, v196, v197
    v_max3_u32 v2, v2, v198, v199
    v_max3_u32 v2, v2, v3, 1
    v_cmp_eq_u32 vcc, -1, v2
    s_nop 1
    s_cbranch_vccnz A_O16
    s_bitset0_b32 s47, 6
    v_mfma_f32_32x32x16_bf16 v[16:31], v[128:131], v[192:195], v[16:31]
    v_mfma_f32_32x32x16_bf16 v[32:47], v[128:131], v[196:199], v[32:47]
    v_mfma_f32_32x32x16_bf16 v[48:63], v[132:135], v[192:195], v[48:63]
    v_mfma_f32_32x32x16_bf16 v[64:79], v[132:135], v[196:199], v[64:79]
A_O16:
    v_max3_u32 v2, v200, v201, v202
    v_max3_u32 v3, v203, v204, v205
    v_max3_u32 v2, v2, v206, v207
    v_max3_u32 v2, v2, v3, 1
    v_cmp_eq_u32 vcc, -1, v2
    s_nop 1
    s_cbranch_vccnz A_O17
    s_bitset0_b32 s47, 7
    v_mfma_f32_32x32x16_bf16 v[16:31], v[136:139], v[200:203], v[16:31]
    v_mfma_f32_32x32x16_bf16 v[32:47], v[136:139], v[204:207], v[32:47]
    v_mfma_f32_32x32x16_bf16 v[48:63], v[140:143], v[200:203], v[48:63]
    v_mfma_f32_32x32x16_bf16 v[64:79], v[140:143], v[204:207], v[64:79]
A_O17:
    s_max_u32 s45, s92, s93
    s_bcnt1_i32_b32 s40, s47
    s_cmp_le_u32 s40, 3
    s_cbranch_scc1 A_F2E
    s_cmp_lg_u32 s47, 0xff
    s_cbranch_scc1 A_F2Q
A_F2P:
    s_mov_b64 exec, 0xff
    buffer_load_dword v4, v5, s[16:19], s45 offen sc1
    s_mov_b64 exec, -1
    s_add_u32 s51, s51, 1
    s_waitcnt vmcnt(0)
    v_cmp_ne_u32 vcc, -1, v4
    s_cmp_ge_u32 s51, 65536
    s_cbranch_scc1 A_F2Q
    s_and_b32 s40, vcc_lo, 0xff
    s_bcnt1_i32_b32 s40, s40
    s_cmp_ge_u32 s40, 1
    s_cbranch_scc1 A_F2Q
    s_sleep 4
    s_branch A_F2P
A_F2Q:
    s_mov_b32 s46, 0
A_F2:
    s_bitcmp1_b32 s47, 0
    s_cbranch_scc0 A_F2L0
    buffer_load_dwordx4 v[144:147], v1, s[16:19], s92 offen offset:0 sc1
    buffer_load_dwordx4 v[148:151], v1, s[16:19], s93 offen offset:0 sc1
A_F2L0:
    s_bitcmp1_b32 s47, 1
    s_cbranch_scc0 A_F2L1
    buffer_load_dwordx4 v[152:155], v1, s[16:19], s92 offen offset:1024 sc1
    buffer_load_dwordx4 v[156:159], v1, s[16:19], s93 offen offset:1024 sc1
A_F2L1:
    s_bitcmp1_b32 s47, 2
    s_cbranch_scc0 A_F2L2
    buffer_load_dwordx4 v[160:163], v1, s[16:19], s92 offen offset:2048 sc1
    buffer_load_dwordx4 v[164:167], v1, s[16:19], s93 offen offset:2048 sc1
A_F2L2:
    s_bitcmp1_b32 s47, 3
    s_cbranch_scc0 A_F2L3
    buffer_load_dwordx4 v[168:171], v1, s[16:19], s92 offen offset:3072 sc1
    buffer_load_dwordx4 v[172:175], v1, s[16:19], s93 offen offset:3072 sc1
A_F2L3:
    s_bitcmp1_b32 s47, 4
    s_cbranch_scc0 A_F2L4
    buffer_load_dwordx4 v[176:179], v10, s[16:19], s92 offen offset:0 sc1
    buffer_load_dwordx4 v[180:183], v10, s[16:19], s93 offen offset:0 sc1
A_F2L4:
    s_bitcmp1_b32 s47, 5
    s_cbranch_scc0 A_F2L5
    buffer_load_dwordx4 v[184:187], v10, s[16:19], s92 offen offset:1024 sc1
    buffer_load_dwordx4 v[188:191], v10, s[16:19], s93 offen offset:1024 sc1
A_F2L5:
    s_bitcmp1_b32 s47, 6
    s_cbranch_scc0 A_F2L6
    buffer_load_dwordx4 v[192:195], v10, s[16:19], s92 offen offset:2048 sc1
    buffer_load_dwordx4 v[196:199], v10, s[16:19], s93 offen offset:2048 sc1
A_F2L6:
    s_bitcmp1_b32 s47, 7
    s_cbranch_scc0 A_F2L7
    buffer_load_dwordx4 v[200:203], v10, s[16:19], s92 offen offset:3072 sc1
    buffer_load_dwordx4 v[204:207], v10, s[16:19], s93 offen offset:3072 sc1
A_F2L7:
A_F2M:
    s_bitcmp1_b32 s46, 0
    s_cbranch_scc0 A_F2M0
    v_mfma_f32_32x32x16_bf16 v[16:31], v[80:83], v[144:147], v[16:31]
    v_mfma_f32_32x32x16_bf16 v[32:47], v[80:83], v[148:151], v[32:47]
    v_mfma_f32_32x32x16_bf16 v[48:63], v[84:87], v[144:147], v[48:63]
    v_mfma_f32_32x32x16_bf16 v[64:79], v[84:87], v[148:151], v[64:79]
A_F2M0:
    s_bitcmp1_b32 s46, 1
    s_cbranch_scc0 A_F2M1
    v_mfma_f32_32x32x16_bf16 v[16:31], v[88:91], v[152:155], v[16:31]
    v_mfma_f32_32x32x16_bf16 v[32:47], v[88:91], v[156:159], v[32:47]
    v_mfma_f32_32x32x16_bf16 v[48:63], v[92:95], v[152:155], v[48:63]
    v_mfma_f32_32x32x16_bf16 v[64:79], v[92:95], v[156:159], v[64:79]
A_F2M1:
    s_bitcmp1_b32 s46, 2
    s_cbranch_scc0 A_F2M2
    v_mfma_f32_32x32x16_bf16 v[16:31], v[96:99], v[160:163], v[16:31]
    v_mfma_f32_32x32x16_bf16 v[32:47], v[96:99], v[164:167], v[32:47]
    v_mfma_f32_32x32x16_bf16 v[48:63], v[100:103], v[160:163], v[48:63]
    v_mfma_f32_32x32x16_bf16 v[64:79], v[100:103], v[164:167], v[64:79]
A_F2M2:
    s_bitcmp1_b32 s46, 3
    s_cbranch_scc0 A_F2M3
    v_mfma_f32_32x32x16_bf16 v[16:31], v[104:107], v[168:171], v[16:31]
    v_mfma_f32_32x32x16_bf16 v[32:47], v[104:107], v[172:175], v[32:47]
    v_mfma_f32_32x32x16_bf16 v[48:63], v[108:111], v[168:171], v[48:63]
    v_mfma_f32_32x32x16_bf16 v[64:79], v[108:111], v[172:175], v[64:79]
A_F2M3:
    s_bitcmp1_b32 s46, 4
    s_cbranch_scc0 A_F2M4
    v_mfma_f32_32x32x16_bf16 v[16:31], v[112:115], v[176:179], v[16:31]
    v_mfma_f32_32x32x16_bf16 v[32:47], v[112:115], v[180:183], v[32:47]
    v_mfma_f32_32x32x16_bf16 v[48:63], v[116:119], v[176:179], v[48:63]
    v_mfma_f32_32x32x16_bf16 v[64:79], v[116:119], v[180:183], v[64:79]
A_F2M4:
    s_bitcmp1_b32 s46, 5
    s_cbranch_scc0 A_F2M5
    v_mfma_f32_32x32x16_bf16 v[16:31], v[120:123], v[184:187], v[16:31]
    v_mfma_f32_32x32x16_bf16 v[32:47], v[120:123], v[188:191], v[32:47]
    v_mfma_f32_32x32x16_bf16 v[48:63], v[124:127], v[184:187], v[48:63]
    v_mfma_f32_32x32x16_bf16 v[64:79], v[124:127], v[188:191], v[64:79]
A_F2M5:
    s_bitcmp1_b32 s46, 6
    s_cbranch_scc0 A_F2M6
    v_mfma_f32_32x32x16_bf16 v[16:31], v[128:131], v[192:195], v[16:31]
    v_mfma_f32_32x32x16_bf16 v[32:47], v[128:131], v[196:199], v[32:47]
    v_mfma_f32_32x32x16_bf16 v[48:63], v[132:135], v[192:195], v[48:63]
    v_mfma_f32_32x32x16_bf16 v[64:79], v[132:135], v[196:199], v[64:79]
A_F2M6:
    s_bitcmp1_b32 s46, 7
    s_cbranch_scc0 A_F2M7
    v_mfma_f32_32x32x16_bf16 v[16:31], v[136:139], v[200:203], v[16:31]
    v_mfma_f32_32x32x16_bf16 v[32:47], v[136:139], v[204:207], v[32:47]
    v_mfma_f32_32x32x16_bf16 v[48:63], v[140:143], v[200:203], v[48:63]
    v_mfma_f32_32x32x16_bf16 v[64:79], v[140:143], v[204:207], v[64:79]
A_F2M7:
    s_bcnt1_i32_b32 s40, s47
    s_cmp_le_u32 s40, 3
    s_cbranch_scc1 A_F2E
A_F2W:
    s_add_u32 s51, s51, 1
    s_cmp_ge_u32 s51, 65536
    s_cselect_b32 s50, 0, -1
    s_mov_b32 s46, s47
    s_waitcnt vmcnt(0)
    s_bitcmp1_b32 s47, 0
    s_cbranch_scc0 A_F2C0
    v_max3_u32 v2, v144, v145, v146
    v_max3_u32 v3, v147, v148, v149
    v_max3_u32 v2, v2, v150, v151
    v_max3_u32 v2, v2, v3, 1
    v_cmp_eq_u32 vcc, s50, v2
    s_nop 1
    s_cbranch_vccnz A_F2C0
    s_bitset0_b32 s47, 0
A_F2C0:
    s_bitcmp1_b32 s47, 1
    s_cbranch_scc0 A_F2C1
    v_max3_u32 v2, v152, v153, v154
    v_max3_u32 v3, v155, v156, v157
    v_max3_u32 v2, v2, v158, v159
    v_max3_u32 v2, v2, v3, 1
    v_cmp_eq_u32 vcc, s50, v2
    s_nop 1
    s_cbranch_vccnz A_F2C1
    s_bitset0_b32 s47, 1
A_F2C1:
    s_bitcmp1_b32 s47, 2
    s_cbranch_scc0 A_F2C2
    v_max3_u32 v2, v160, v161, v162
    v_max3_u32 v3, v163, v164, v165
    v_max3_u32 v2, v2, v166, v167
    v_max3_u32 v2, v2, v3, 1
    v_cmp_eq_u32 vcc, s50, v2
    s_nop 1
    s_cbranch_vccnz A_F2C2
    s_bitset0_b32 s47, 2
A_F2C2:
    s_bitcmp1_b32 s47, 3
    s_cbranch_scc0 A_F2C3
    v_max3_u32 v2, v168, v169, v170
    v_max3_u32 v3, v171, v172, v173
    v_max3_u32 v2, v2, v174, v175
    v_max3_u32 v2, v2, v3, 1
    v_cmp_eq_u32 vcc, s50, v2
    s_nop 1
    s_cbranch_vccnz A_F2C3
    s_bitset0_b32 s47, 3
A_F2C3:
    s_bitcmp1_b32 s47, 4
    s_cbranch_scc0 A_F2C4
    v_max3_u32 v2, v176, v177, v178
    v_max3_u32 v3, v179, v180, v181
    v_max3_u32 v2, v2, v182, v183
    v_max3_u32 v2, v2, v3, 1
    v_cmp_eq_u32 vcc, s50, v2
    s_nop 1
    s_cbranch_vccnz A_F2C4
    s_bitset0_b32 s47, 4
A_F2C4:
    s_bitcmp1_b32 s47, 5
    s_cbranch_scc0 A_F2C5
    v_max3_u32 v2, v184, v185, v186
    v_max3_u32 v3, v187, v188, v189
    v_max3_u32 v2, v2, v190, v191
    v_max3_u32 v2, v2, v3, 1
    v_cmp_eq_u32 vcc, s50, v2
    s_nop 1
    s_cbranch_vccnz A_F2C5
    s_bitset0_b32 s47, 5
A_F2C5:
    s_bitcmp1_b32 s47, 6
    s_cbranch_scc0 A_F2C6
    v_max3_u32 v2, v192, v193, v194
    v_max3_u32 v3, v195, v196, v197
    v_max3_u32 v2, v2, v198, v199
    v_max3_u32 v2, v2, v3, 1
    v_cmp_eq_u32 vcc, s50, v2
    s_nop 1
    s_cbranch_vccnz A_F2C6
    s_bitset0_b32 s47, 6
A_F2C6:
    s_bitcmp1_b32 s47, 7
    s_cbranch_scc0 A_F2C7
    v_max3_u32 v2, v200, v201, v202
    v_max3_u32 v3, v203, v204, v205
    v_max3_u32 v2, v2, v206, v207
    v_max3_u32 v2, v2, v3, 1
    v_cmp_eq_u32 vcc, s50, v2
    s_nop 1
    s_cbranch_vccnz A_F2C7
    s_bitset0_b32 s47, 7
A_F2C7:
    s_andn2_b32 s46, s46, s47
    s_bcnt1_i32_b32 s40, s47
    s_cmp_le_u32 s40, 3
    s_cbranch_scc1 A_F2M
    s_cmp_eq_u32 s47, 0xff
    s_cbranch_scc1 A_F2P
    s_branch A_F2
A_F2E:
    s_lshl_b32 s40, s36, 3
    s_lshl_b32 s40, s47, s40
    v_mov_b32 v2, s40
    v_mov_b32 v3, 135312
    s_lshl_b32 s41, s36, 13
    s_sub_u32 s90, s90, s41
    s_sub_u32 s92, s92, s41
    s_lshl_b32 exec_lo, 1, s36
    s_mov_b32 exec_hi, 0
    ds_write_b32 v8, v2 offset:32
    s_mov_b64 exec, -1
    s_nop 3
    ds_write_b128 v9, v[32:35] offset:0
    ds_write_b128 v9, v[36:39] offset:1024
    ds_write_b128 v9, v[40:43] offset:2048
    ds_write_b128 v9, v[44:47] offset:3072
    ds_write_b128 v9, v[48:51] offset:16384
    ds_write_b128 v9, v[52:55] offset:17408
    ds_write_b128 v9, v[56:59] offset:18432
    ds_write_b128 v9, v[60:63] offset:19456
    ds_write_b128 v9, v[64:67] offset:32768
    ds_write_b128 v9, v[68:71] offset:33792
    ds_write_b128 v9, v[72:75] offset:34816
    ds_write_b128 v9, v[76:79] offset:35840
    s_waitcnt lgkmcnt(0)
    s_barrier
    ds_read_b128 v[2:5], v3
    ds_read_b128 v[32:35], v11 offset:0
    ds_read_b128 v[36:39], v11 offset:1024
    ds_read_b128 v[40:43], v11 offset:2048
    ds_read_b128 v[44:47], v11 offset:3072
    ds_read_b128 v[48:51], v12 offset:16384
    ds_read_b128 v[52:55], v12 offset:17408
    ds_read_b128 v[56:59], v12 offset:18432
    ds_read_b128 v[60:63], v12 offset:19456
    ds_read_b128 v[64:67], v14 offset:32768
    ds_read_b128 v[68:71], v14 offset:33792
    ds_read_b128 v[72:75], v14 offset:34816
    ds_read_b128 v[76:79], v14 offset:35840
    s_waitcnt lgkmcnt(12)
    v_or3_b32 v2, v2, v3, v4
    v_or_b32 v2, v2, v5
    s_mov_b32 s47, 0
    s_nop 0
    v_readfirstlane_b32 s46, v2
    s_cmp_eq_u32 s46, 0
    s_cbranch_scc1 A_B0
    s_ff1_i32_b32 s40, s46
    s_bitset0_b32 s46, s40
    s_lshl_b32 s40, s40, 10
    s_add_u32 s20, s40, s92
    s_add_u32 s40, s40, s90
    s_bitset1_b32 s47, 0
    buffer_load_dwordx4 v[80:83], v1, s[16:19], s40 offen sc1
    buffer_load_dwordx4 v[84:87], v1, s[16:19], s20 offen sc1
    s_cmp_eq_u32 s46, 0
    s_cbranch_scc1 A_B0
    s_ff1_i32_b32 s40, s46
    s_bitset0_b32 s46, s40
    s_lshl_b32 s40, s40, 10
    s_add_u32 s21, s40, s92
    s_add_u32 s40, s40, s90
    s_bitset1_b32 s47, 1
    buffer_load_dwordx4 v[88:91], v1, s[16:19], s40 offen sc1
    buffer_load_dwordx4 v[92:95], v1, s[16:19], s21 offen sc1
    s_cmp_eq_u32 s46, 0
    s_cbranch_scc1 A_B0
    s_ff1_i32_b32 s40, s46
    s_bitset0_b32 s46, s40
    s_lshl_b32 s40, s40, 10
    s_add_u32 s22, s40, s92
    s_add_u32 s40, s40, s90
    s_bitset1_b32 s47, 2
    buffer_load_dwordx4 v[96:99], v1, s[16:19], s40 offen sc1
    buffer_load_dwordx4 v[100:103], v1, s[16:19], s22 offen sc1
    s_cmp_eq_u32 s46, 0
    s_cbranch_scc1 A_B0
    s_ff1_i32_b32 s40, s46
    s_bitset0_b32 s46, s40
    s_lshl_b32 s40, s40, 10
    s_add_u32 s23, s40, s92
    s_add_u32 s40, s40, s90
    s_bitset1_b32 s47, 3
    buffer_load_dwordx4 v[104:107], v1, s[16:19], s40 offen sc1
    buffer_load_dwordx4 v[108:111], v1, s[16:19], s23 offen sc1
    s_cmp_eq_u32 s46, 0
    s_cbranch_scc1 A_B0
    s_ff1_i32_b32 s40, s46
    s_bitset0_b32 s46, s40
    s_lshl_b32 s40, s40, 10
    s_add_u32 s24, s40, s92
    s_add_u32 s40, s40, s90
    s_bitset1_b32 s47, 4
    buffer_load_dwordx4 v[112:115], v1, s[16:19], s40 offen sc1
    buffer_load_dwordx4 v[116:119], v1, s[16:19], s24 offen sc1
    s_cmp_eq_u32 s46, 0
    s_cbranch_scc1 A_B0
    s_ff1_i32_b32 s40, s46
    s_bitset0_b32 s46, s40
    s_lshl_b32 s40, s40, 10
    s_add_u32 s25, s40, s92
    s_add_u32 s40, s40, s90
    s_bitset1_b32 s47, 5
    buffer_load_dwordx4 v[120:123], v1, s[16:19], s40 offen sc1
    buffer_load_dwordx4 v[124:127], v1, s[16:19], s25 offen sc1
    s_cmp_eq_u32 s46, 0
    s_cbranch_scc1 A_B0
    s_ff1_i32_b32 s40, s46
    s_bitset0_b32 s46, s40
    s_lshl_b32 s40, s40, 10
    s_add_u32 s26, s40, s92
    s_add_u32 s40, s40, s90
    s_bitset1_b32 s47, 6
    buffer_load_dwordx4 v[128:131], v1, s[16:19], s40 offen sc1
    buffer_load_dwordx4 v[132:135], v1, s[16:19], s26 offen sc1
    s_cmp_eq_u32 s46, 0
    s_cbranch_scc1 A_B0
    s_ff1_i32_b32 s40, s46
    s_bitset0_b32 s46, s40
    s_lshl_b32 s40, s40, 10
    s_add_u32 s27, s40, s92
    s_add_u32 s40, s40, s90
    s_bitset1_b32 s47, 7
    buffer_load_dwordx4 v[136:139], v1, s[16:19], s40 offen sc1
    buffer_load_dwordx4 v[140:143], v1, s[16:19], s27 offen sc1
    s_cmp_eq_u32 s46, 0
    s_cbranch_scc1 A_B0
    s_ff1_i32_b32 s40, s46
    s_bitset0_b32 s46, s40
    s_lshl_b32 s40, s40, 10
    s_add_u32 s28, s40, s92
    s_add_u32 s40, s40, s90
    s_bitset1_b32 s47, 8
    buffer_load_dwordx4 v[144:147], v1, s[16:19], s40 offen sc1
    buffer_load_dwordx4 v[148:151], v1, s[16:19], s28 offen sc1
    s_cmp_eq_u32 s46, 0
    s_cbranch_scc1 A_B0
    s_ff1_i32_b32 s40, s46
    s_bitset0_b32 s46, s40
    s_lshl_b32 s40, s40, 10
    s_add_u32 s29, s40, s92
    s_add_u32 s40, s40, s90
    s_bitset1_b32 s47, 9
    buffer_load_dwordx4 v[152:155], v1, s[16:19], s40 offen sc1
    buffer_load_dwordx4 v[156:159], v1, s[16:19], s29 offen sc1
    s_cmp_eq_u32 s46, 0
    s_cbranch_scc1 A_B0
    s_ff1_i32_b32 s40, s46
    s_bitset0_b32 s46, s40
    s_lshl_b32 s40, s40, 10
    s_add_u32 s30, s40, s92
    s_add_u32 s40, s40, s90
    s_bitset1_b32 s47, 10
    buffer_load_dwordx4 v[160:163], v1, s[16:19], s40 offen sc1
    buffer_load_dwordx4 v[164:167], v1, s[16:19], s30 offen sc1
    s_cmp_eq_u32 s46, 0
    s_cbranch_scc1 A_B0
    s_ff1_i32_b32 s40, s46
    s_bitset0_b32 s46, s40
    s_lshl_b32 s40, s40, 10
    s_add_u32 s31, s40, s92
    s_add_u32 s40, s40, s90
    s_bitset1_b32 s47, 11
    buffer_load_dwordx4 v[168:171], v1, s[16:19], s40 offen sc1
    buffer_load_dwordx4 v[172:175], v1, s[16:19], s31 offen sc1
A_B0:
    s_waitcnt lgkmcnt(8)
    v_add_f32 v16, v16, v32
    v_add_f32 v17, v17, v33
    v_add_f32 v18, v18, v34
    v_add_f32 v19, v19, v35
    v_add_f32 v20, v20, v36
    v_add_f32 v21, v21, v37
    v_add_f32 v22, v22, v38
    v_add_f32 v23, v23, v39
    v_add_f32 v24, v24, v40
    v_add_f32 v25, v25, v41
    v_add_f32 v26, v26, v42
    v_add_f32 v27, v27, v43
    v_add_f32 v28, v28, v44
    v_add_f32 v29, v29, v45
    v_add_f32 v30, v30, v46
    v_add_f32 v31, v31, v47
    s_waitcnt lgkmcnt(0)
    v_add_f32 v48, v48, v64
    v_add_f32 v49, v49, v65
    v_add_f32 v50, v50, v66
    v_add_f32 v51, v51, v67
    v_add_f32 v52, v52, v68
    v_add_f32 v53, v53, v69
    v_add_f32 v54, v54, v70
    v_add_f32 v55, v55, v71
    v_add_f32 v56, v56, v72
    v_add_f32 v57, v57, v73
    v_add_f32 v58, v58, v74
    v_add_f32 v59, v59, v75
    v_add_f32 v60, v60, v76
    v_add_f32 v61, v61, v77
    v_add_f32 v62, v62, v78
    v_add_f32 v63, v63, v79
    v_add_f32 v16, v16, v48
    v_add_f32 v17, v17, v49
    v_add_f32 v18, v18, v50
    v_add_f32 v19, v19, v51
    v_add_f32 v20, v20, v52
    v_add_f32 v21, v21, v53
    v_add_f32 v22, v22, v54
    v_add_f32 v23, v23, v55
    v_add_f32 v24, v24, v56
    v_add_f32 v25, v25, v57
    v_add_f32 v26, v26, v58
    v_add_f32 v27, v27, v59
    v_add_f32 v28, v28, v60
    v_add_f32 v29, v29, v61
    v_add_f32 v30, v30, v62
    v_add_f32 v31, v31, v63
    s_cmp_eq_u32 s47, 0
    s_cbranch_scc1 A_BE
A_B1:
    s_add_u32 s51, s51, 1
    s_cmp_ge_u32 s51, 65536
    s_cselect_b32 s50, 0, -1
    s_waitcnt vmcnt(0)
    s_lshr_b32 s40, s47, 0
    s_cbranch_scc0 A_B2
    s_bitcmp1_b32 s47, 0
    s_cbranch_scc0 A_BC0
    v_max3_u32 v2, v84, v85, 1
    v_max3_u32 v2, v2, v86, v87
    v_cmp_eq_u32 vcc, s50, v2
    s_nop 1
    s_cbranch_vccz A_BD0
    buffer_load_dwordx4 v[84:87], v1, s[16:19], s20 offen sc1
    s_branch A_BC0
A_BD0:
    s_bitset0_b32 s47, 0
    v_mfma_f32_32x32x16_bf16 v[16:31], v[80:83], v[84:87], v[16:31]
A_BC0:
    s_lshr_b32 s40, s47, 1
    s_cbranch_scc0 A_B2
    s_bitcmp1_b32 s47, 1
    s_cbranch_scc0 A_BC1
    v_max3_u32 v2, v92, v93, 1
    v_max3_u32 v2, v2, v94, v95
    v_cmp_eq_u32 vcc, s50, v2
    s_nop 1
    s_cbranch_vccz A_BD1
    buffer_load_dwordx4 v[92:95], v1, s[16:19], s21 offen sc1
    s_branch A_BC1
A_BD1:
    s_bitset0_b32 s47, 1
    v_mfma_f32_32x32x16_bf16 v[16:31], v[88:91], v[92:95], v[16:31]
A_BC1:
    s_lshr_b32 s40, s47, 2
    s_cbranch_scc0 A_B2
    s_bitcmp1_b32 s47, 2
    s_cbranch_scc0 A_BC2
    v_max3_u32 v2, v100, v101, 1
    v_max3_u32 v2, v2, v102, v103
    v_cmp_eq_u32 vcc, s50, v2
    s_nop 1
    s_cbranch_vccz A_BD2
    buffer_load_dwordx4 v[100:103], v1, s[16:19], s22 offen sc1
    s_branch A_BC2
A_BD2:
    s_bitset0_b32 s47, 2
    v_mfma_f32_32x32x16_bf16 v[16:31], v[96:99], v[100:103], v[16:31]
A_BC2:
    s_lshr_b32 s40, s47, 3
    s_cbranch_scc0 A_B2
    s_bitcmp1_b32 s47, 3
    s_cbranch_scc0 A_BC3
    v_max3_u32 v2, v108, v109, 1
    v_max3_u32 v2, v2, v110, v111
    v_cmp_eq_u32 vcc, s50, v2
    s_nop 1
    s_cbranch_vccz A_BD3
    buffer_load_dwordx4 v[108:111], v1, s[16:19], s23 offen sc1
    s_branch A_BC3
A_BD3:
    s_bitset0_b32 s47, 3
    v_mfma_f32_32x32x16_bf16 v[16:31], v[104:107], v[108:111], v[16:31]
A_BC3:
    s_lshr_b32 s40, s47, 4
    s_cbranch_scc0 A_B2
    s_bitcmp1_b32 s47, 4
    s_cbranch_scc0 A_BC4
    v_max3_u32 v2, v116, v117, 1
    v_max3_u32 v2, v2, v118, v119
    v_cmp_eq_u32 vcc, s50, v2
    s_nop 1
    s_cbranch_vccz A_BD4
    buffer_load_dwordx4 v[116:119], v1, s[16:19], s24 offen sc1
    s_branch A_BC4
A_BD4:
    s_bitset0_b32 s47, 4
    v_mfma_f32_32x32x16_bf16 v[16:31], v[112:115], v[116:119], v[16:31]
A_BC4:
    s_lshr_b32 s40, s47, 5
    s_cbranch_scc0 A_B2
    s_bitcmp1_b32 s47, 5
    s_cbranch_scc0 A_BC5
    v_max3_u32 v2, v124, v125, 1
    v_max3_u32 v2, v2, v126, v127
    v_cmp_eq_u32 vcc, s50, v2
    s_nop 1
    s_cbranch_vccz A_BD5
    buffer_load_dwordx4 v[124:127], v1, s[16:19], s25 offen sc1
    s_branch A_BC5
A_BD5:
    s_bitset0_b32 s47, 5
    v_mfma_f32_32x32x16_bf16 v[16:31], v[120:123], v[124:127], v[16:31]
A_BC5:
    s_lshr_b32 s40, s47, 6
    s_cbranch_scc0 A_B2
    s_bitcmp1_b32 s47, 6
    s_cbranch_scc0 A_BC6
    v_max3_u32 v2, v132, v133, 1
    v_max3_u32 v2, v2, v134, v135
    v_cmp_eq_u32 vcc, s50, v2
    s_nop 1
    s_cbranch_vccz A_BD6
    buffer_load_dwordx4 v[132:135], v1, s[16:19], s26 offen sc1
    s_branch A_BC6
A_BD6:
    s_bitset0_b32 s47, 6
    v_mfma_f32_32x32x16_bf16 v[16:31], v[128:131], v[132:135], v[16:31]
A_BC6:
    s_lshr_b32 s40, s47, 7
    s_cbranch_scc0 A_B2
    s_bitcmp1_b32 s47, 7
    s_cbranch_scc0 A_BC7
    v_max3_u32 v2, v140, v141, 1
    v_max3_u32 v2, v2, v142, v143
    v_cmp_eq_u32 vcc, s50, v2
    s_nop 1
    s_cbranch_vccz A_BD7
    buffer_load_dwordx4 v[140:143], v1, s[16:19], s27 offen sc1
    s_branch A_BC7
A_BD7:
    s_bitset0_b32 s47, 7
    v_mfma_f32_32x32x16_bf16 v[16:31], v[136:139], v[140:143], v[16:31]
A_BC7:
    s_lshr_b32 s40, s47, 8
    s_cbranch_scc0 A_B2
    s_bitcmp1_b32 s47, 8
    s_cbranch_scc0 A_BC8
    v_max3_u32 v2, v148, v149, 1
    v_max3_u32 v2, v2, v150, v151
    v_cmp_eq_u32 vcc, s50, v2
    s_nop 1
    s_cbranch_vccz A_BD8
    buffer_load_dwordx4 v[148:151], v1, s[16:19], s28 offen sc1
    s_branch A_BC8
A_BD8:
    s_bitset0_b32 s47, 8
    v_mfma_f32_32x32x16_bf16 v[16:31], v[144:147], v[148:151], v[16:31]
A_BC8:
    s_lshr_b32 s40, s47, 9
    s_cbranch_scc0 A_B2
    s_bitcmp1_b32 s47, 9
    s_cbranch_scc0 A_BC9
    v_max3_u32 v2, v156, v157, 1
    v_max3_u32 v2, v2, v158, v159
    v_cmp_eq_u32 vcc, s50, v2
    s_nop 1
    s_cbranch_vccz A_BD9
    buffer_load_dwordx4 v[156:159], v1, s[16:19], s29 offen sc1
    s_branch A_BC9
A_BD9:
    s_bitset0_b32 s47, 9
    v_mfma_f32_32x32x16_bf16 v[16:31], v[152:155], v[156:159], v[16:31]
A_BC9:
    s_lshr_b32 s40, s47, 10
    s_cbranch_scc0 A_B2
    s_bitcmp1_b32 s47, 10
    s_cbranch_scc0 A_BC10
    v_max3_u32 v2, v164, v165, 1
    v_max3_u32 v2, v2, v166, v167
    v_cmp_eq_u32 vcc, s50, v2
    s_nop 1
    s_cbranch_vccz A_BD10
    buffer_load_dwordx4 v[164:167], v1, s[16:19], s30 offen sc1
    s_branch A_BC10
A_BD10:
    s_bitset0_b32 s47, 10
    v_mfma_f32_32x32x16_bf16 v[16:31], v[160:163], v[164:167], v[16:31]
A_BC10:
    s_lshr_b32 s40, s47, 11
    s_cbranch_scc0 A_B2
    s_bitcmp1_b32 s47, 11
    s_cbranch_scc0 A_BC11
    v_max3_u32 v2, v172, v173, 1
    v_max3_u32 v2, v2, v174, v175
    v_cmp_eq_u32 vcc, s50, v2
    s_nop 1
    s_cbranch_vccz A_BD11
    buffer_load_dwordx4 v[172:175], v1, s[16:19], s31 offen sc1
    s_branch A_BC11
A_BD11:
    s_bitset0_b32 s47, 11
    v_mfma_f32_32x32x16_bf16 v[16:31], v[168:171], v[172:175], v[16:31]
A_BC11:
A_B2:
    s_cmp_lg_u32 s47, 0
    s_cbranch_scc1 A_B1
    s_nop 7
    s_nop 7
A_BE:
    v_mul_f32 v16, v7, v16
    v_mul_f32 v17, v7, v17
    v_mul_f32 v18, v7, v18
    v_mul_f32 v19, v7, v19
    v_mul_f32 v20, v7, v20
    v_mul_f32 v21, v7, v21
    v_mul_f32 v22, v7, v22
    v_mul_f32 v23, v7, v23
    v_mul_f32 v24, v7, v24
    v_mul_f32 v25, v7, v25
    v_mul_f32 v26, v7, v26
    v_mul_f32 v27, v7, v27
    v_mul_f32 v28, v7, v28
    v_mul_f32 v29, v7, v29
    v_mul_f32 v30, v7, v30
    v_mul_f32 v31, v7, v31
    v_cvt_pk_bf16_f32 v32, v16, v17
    v_cvt_pk_bf16_f32 v33, v18, v19
    v_cvt_pk_bf16_f32 v34, v20, v21
    v_cvt_pk_bf16_f32 v35, v22, v23
    v_cvt_pk_bf16_f32 v36, v24, v25
    v_cvt_pk_bf16_f32 v37, v26, v27
    v_cvt_pk_bf16_f32 v38, v28, v29
    v_cvt_pk_bf16_f32 v39, v30, v31
    buffer_store_dwordx4 v[32:35], v13, s[68:71], s44 offen
    buffer_store_dwordx4 v[36:39], v13, s[68:71], s44 offen offset:32
    s_endpgm
A_GD0:
    s_add_u32 m0, s96, 73728
    s_nop 0
    buffer_load_ushort v40, s[64:67], s43 offen lds
    s_branch A_GE0
A_GD9:
    s_add_u32 m0, s96, 98304
    s_nop 0
    buffer_load_ushort v40, s[64:67], s43 offen lds
    s_branch A_GE9
A_GD10:
    s_add_u32 m0, s96, 122880
    s_nop 0
    buffer_load_ushort v40, s[64:67], s43 offen lds
    s_branch A_GE10
A_GD11:
    s_add_u32 m0, s96, 147456
    s_nop 0
    buffer_load_ushort v40, s[64:67], s43 offen lds
    s_branch A_GE11
A_GD12:
    s_add_u32 m0, s96, 73728
    s_nop 0
    buffer_load_ushort v40, s[64:67], s43 offen lds
    s_branch A_GE12
A_GD13:
    s_add_u32 m0, s96, 98304
    s_nop 0
    buffer_load_ushort v40, s[64:67], s43 offen lds
    s_branch A_GE13
A_GD14:
    s_add_u32 m0, s96, 122880
    s_nop 0
    buffer_load_ushort v40, s[64:67], s43 offen lds
    s_branch A_GE14
A_GD15:
    s_add_u32 m0, s96, 147456
    s_nop 0
    buffer_load_ushort v40, s[64:67], s43 offen lds
    s_branch A_GE15
M_MAIN:
    s_setprio 2
    v_and_b32 v2, 27, v0
    v_cmp_eq_u32 vcc, 16, v2
    v_mov_b32 v2, 0
    v_mov_b32 v3, 0x3f803f80
    s_nop 0
    v_cndmask_b32 v2, v2, v3, vcc
    v_mov_b32 v3, v2
    v_mov_b64 v[24:25], v[2:3]
    v_mov_b64 v[26:27], v[2:3]
    v_mov_b64 v[28:29], v[2:3]
    v_mov_b64 v[30:31], v[2:3]
    v_mov_b64 v[32:33], v[2:3]
    v_mov_b64 v[34:35], v[2:3]
    v_mov_b64 v[36:37], v[2:3]
    v_mov_b64 v[38:39], v[2:3]
    v_mov_b64 v[80:81], 0
    v_mov_b64 v[82:83], 0
    v_mov_b64 v[84:85], 0
    v_mov_b64 v[86:87], 0
    v_mov_b64 v[88:89], 0
    v_mov_b64 v[90:91], 0
    v_mov_b64 v[92:93], 0
    v_mov_b64 v[94:95], 0
    v_mov_b64 v[96:97], 0
    v_mov_b64 v[98:99], 0
    v_mov_b64 v[100:101], 0
    v_mov_b64 v[102:103], 0
    v_mov_b64 v[104:105], 0
    v_mov_b64 v[106:107], 0
    v_mov_b64 v[108:109], 0
    v_mov_b64 v[110:111], 0
    s_waitcnt lgkmcnt(0)
    s_mov_b32 s16, s78
    s_and_b32 s17, s79, 0xffff
    s_mov_b32 s18, 0x116a000
    s_mov_b32 s19, 0x00020000
    s_mov_b32 s72, s76
    s_and_b32 s73, s77, 0xffff
    s_mov_b32 s74, 0x100
    s_mov_b32 s75, 0x00020000
    v_mov_b32 v22, 0
    s_or_b32 s40, s2, s36
    s_cmp_lg_u32 s40, 0
    s_cbranch_scc1 M_NOEP
    s_memrealtime s[40:41]
    s_waitcnt lgkmcnt(0)
    s_or_b32 s40, s40, 1
    v_mov_b32 v3, s40
    s_mov_b64 exec, 1
    buffer_store_dword v3, v22, s[72:75], 0 offen sc1
    s_mov_b64 exec, -1
M_NOEP:
    s_lshr_b32 s87, s36, 1
    s_and_b32 s88, s36, 1
    v_and_b32 v8, 15, v0
    v_lshrrev_b32 v9, 4, v0
    v_lshrrev_b32 v10, 1, v8
    v_xor_b32 v10, v10, v9
    v_lshlrev_b32 v10, 4, v10
    v_lshl_add_u32 v17, v8, 7, v10
    v_xor_b32 v18, 64, v17
    v_lshlrev_b32 v10, 3, v9
    v_bfe_u32 v2, v0, 2, 2
    v_add_u32 v10, v10, v2
    v_and_b32 v3, 1, v9
    v_lshrrev_b32 v2, 1, v2
    v_lshl_or_b32 v2, v3, 1, v2
    v_lshlrev_b32 v2, 5, v2
    v_lshl_add_u32 v5, v10, 7, v2
    v_and_b32 v4, 3, v0
    v_lshl_add_u32 v6, v4, 3, v5
    s_lshl_b32 s40, s36, 5
    v_xor_b32 v19, s40, v6
    v_add_u32 v21, 106496, v19
    v_bfe_u32 v4, v0, 1, 1
    v_lshl_add_u32 v19, v4, 13, v19
    v_add_u32 v19, 90112, v19
    v_xor_b32 v20, 16, v19
    s_lshl_b32 s40, s88, 13
    s_add_u32 s40, s40, 73728
    v_add_u32 v40, s40, v6
    v_lshrrev_b32 v4, 2, v0
    v_lshl_add_u32 v4, v4, 3, s40
    s_cmp_eq_u32 s94, 14
    s_cselect_b64 vcc, -1, 0
    v_cndmask_b32 v40, v40, v4, vcc
    v_xor_b32 v41, 32, v40
    v_xor_b32 v42, 64, v40
    v_xor_b32 v43, 0x60, v40
    s_lshl_b32 s40, s98, 2
    s_add_u32 s40, s40, s36
    s_lshl_b32 s41, s95, 1
    s_lshl_b32 s42, s40, 6
    s_add_u32 s42, s42, s41
    s_lshl_b32 s43, s42, 10
    s_add_u32 s43, s43, 15990784
    s_lshl_b32 s44, s42, 11
    s_lshl_b32 s62, s42, 6
    s_add_u32 s62, s62, 18087936
    s_xor_b32 s41, s95, s87
    s_lshl_b32 s41, s41, 1
    s_mul_i32 s56, s41, 112
    s_lshl_b32 s45, s94, 3
    s_lshl_b32 s40, s88, 2
    s_add_u32 s45, s45, s40
    s_add_u32 s56, s56, s45
    s_lshl_b32 s56, s56, 10
    s_add_u32 s56, s56, 4194304
    s_add_u32 s58, s56, 114688
    s_lshl_b32 s63, s41, 7
    s_add_u32 s63, s63, 18251776
    v_lshrrev_b32 v10, 5, v0
    v_and_b32 v11, 1, v9
    v_lshlrev_b32 v11, 9, v11
    v_lshlrev_b32 v12, 4, v8
    v_add_u32 v13, s43, v12
    v_add_u32 v13, v13, v11
    v_lshrrev_b32 v14, 3, v8
    v_lshlrev_b32 v14, 8, v14
    v_and_b32 v4, 7, v8
    v_lshlrev_b32 v4, 4, v4
    v_add_u32 v14, v14, v4
    v_add_u32 v14, v14, v11
    v_add_u32 v14, s44, v14
    v_cmp_gt_u32 vcc, 32, v0
    v_mov_b32 v4, 1.0
    v_mov_b32 v5, 0x3eb8aa3b
    v_cndmask_b32 v2, v14, v13, vcc
    v_cndmask_b32 v7, v4, v5, vcc
    v_mov_b32 v4, 128
    v_mov_b32 v5, 256
    v_cndmask_b32 v4, v4, v5, vcc
    v_add_u32 v3, v2, v4
    v_mov_b32 v13, 2048
    v_mov_b32 v14, 1024
    v_cndmask_b32 v13, v13, v14, vcc
    v_add_u32 v4, v2, v13
    v_add_u32 v5, v3, v13
    v_lshlrev_b32 v6, 8, v10
    v_add_u32 v6, v6, v11
    v_add_u32 v6, v6, v12
    v_add_u32 v6, s44, v6
    v_lshlrev_b32 v44, 10, v10
    v_add_u32 v44, v44, v11
    s_lshl_b32 s40, s36, 12
    s_add_u32 s40, s40, 98304
    v_add3_u32 v44, v44, v12, s40
    v_lshlrev_b32 v45, 2, v8
    v_add_u32 v45, s40, v45
    s_lshl_b32 s40, s35, 2
    s_add_u32 s40, s40, s36
    s_lshl_b32 s60, s40, 16
    s_lshl_b32 s41, s34, 10
    s_add_u32 s60, s60, s41
    s_add_u32 s60, s60, 13893632
    s_add_u32 s61, s60, 32768
    s_lshl_b32 s41, s34, 5
    s_add_u32 s41, s41, s40
    s_lshl_b32 s85, s41, 7
    s_add_u32 s85, s85, 18087936
    s_lshl_b32 s86, s41, 11
    s_add_u32 s86, s86, 15990784
    v_mov_b64 v[144:145], 0
    v_mov_b64 v[146:147], 0
    v_mov_b64 v[148:149], 0
    v_mov_b64 v[150:151], 0
    v_mov_b64 v[152:153], 0
    v_mov_b64 v[154:155], 0
    v_mov_b64 v[156:157], 0
    v_mov_b64 v[158:159], 0
    v_mov_b64 v[160:161], 0
    v_mov_b64 v[162:163], 0
    v_mov_b64 v[164:165], 0
    v_mov_b64 v[166:167], 0
    v_mov_b64 v[168:169], 0
    v_mov_b64 v[170:171], 0
    v_mov_b64 v[172:173], 0
    v_mov_b64 v[174:175], 0
    v_mov_b64 v[176:177], 0
    v_mov_b64 v[178:179], 0
    v_mov_b64 v[180:181], 0
    v_mov_b64 v[182:183], 0
    v_mov_b64 v[184:185], 0
    v_mov_b64 v[186:187], 0
    v_mov_b64 v[188:189], 0
    v_mov_b64 v[190:191], 0
    v_mov_b64 v[192:193], 0
    v_mov_b64 v[194:195], 0
    v_mov_b64 v[196:197], 0
    v_mov_b64 v[198:199], 0
    v_mov_b64 v[200:201], 0
    v_mov_b64 v[202:203], 0
    v_mov_b64 v[204:205], 0
    v_mov_b64 v[206:207], 0
    v_mov_b64 v[208:209], 0
    v_mov_b64 v[210:211], 0
    v_mov_b64 v[212:213], 0
    v_mov_b64 v[214:215], 0
    v_mov_b64 v[216:217], 0
    v_mov_b64 v[218:219], 0
    v_mov_b64 v[220:221], 0
    v_mov_b64 v[222:223], 0
    v_mov_b64 v[224:225], 0
    v_mov_b64 v[226:227], 0
    v_mov_b64 v[228:229], 0
    v_mov_b64 v[230:231], 0
    v_mov_b64 v[232:233], 0
    v_mov_b64 v[234:235], 0
    v_mov_b64 v[236:237], 0
    v_mov_b64 v[238:239], 0
    v_mov_b64 v[240:241], 0
    v_mov_b64 v[242:243], 0
    v_mov_b64 v[244:245], 0
    v_mov_b64 v[246:247], 0
    v_mov_b64 v[248:249], 0
    v_mov_b64 v[250:251], 0
    v_mov_b64 v[252:253], 0
    v_mov_b64 v[254:255], 0
    v_mov_b32 v10, v17
    v_mov_b32 v11, v18
    s_lshl_b32 s40, s87, 16
    v_add_u32 v17, s40, v17
    v_add_u32 v18, s40, v18
    s_mov_b32 s41, 0
    s_movk_i32 s89, 24576
    s_mov_b32 s47, 1
    s_mov_b32 s84, 0
    s_mov_b32 s46, 37888
    s_barrier
    s_branch M_F
M_Q:
    ds_read_b128 v[48:51], v10 offset:0
    ds_read_b64_tr_b16 v[112:113], v19 offset:0
    ds_read_b64_tr_b16 v[114:115], v19 offset:512
    ds_read_b128 v[52:55], v10 offset:2048
    ds_read_b128 v[56:59], v10 offset:4096
    ds_read_b128 v[60:63], v10 offset:6144
    ds_read_b64_tr_b16 v[116:117], v20 offset:0
    ds_read_b64_tr_b16 v[118:119], v20 offset:512
    ds_read_b64_tr_b16 v[120:121], v21 offset:0
    ds_read_b64_tr_b16 v[122:123], v21 offset:512
    s_and_b32 s40, s41, 3
    s_cmp_eq_u32 s40, 3
    s_cselect_b32 s42, -73728, s89
    s_waitcnt lgkmcnt(0)
M_L1:
    v_mfma_f32_16x16x32_bf16 v[208:211], v[112:115], v[48:51], v[208:211]
    ds_read_b128 v[64:67], v11 offset:0
    ds_read_b64_tr_b16 v[128:129], v19 offset:4096
    v_mfma_f32_16x16x32_bf16 v[212:215], v[112:115], v[52:55], v[212:215]
    ds_read_b64_tr_b16 v[130:131], v19 offset:4608
    ds_read_b128 v[68:71], v11 offset:2048
    v_mfma_f32_16x16x32_bf16 v[216:219], v[112:115], v[56:59], v[216:219]
    ds_read_b128 v[72:75], v11 offset:4096
    ds_read_b128 v[76:79], v11 offset:6144
    v_mfma_f32_16x16x32_bf16 v[220:223], v[112:115], v[60:63], v[220:223]
    ds_read_b64_tr_b16 v[132:133], v20 offset:4096
    ds_read_b64_tr_b16 v[134:135], v20 offset:4608
    v_mfma_f32_16x16x32_bf16 v[224:227], v[116:119], v[48:51], v[224:227]
    ds_read_b64_tr_b16 v[136:137], v21 offset:4096
    ds_read_b64_tr_b16 v[138:139], v21 offset:4608
    v_mfma_f32_16x16x32_bf16 v[228:231], v[116:119], v[52:55], v[228:231]
    v_add_u32 v10, 0x2000, v10
    v_add_u32 v11, 0x2000, v11
    v_mfma_f32_16x16x32_bf16 v[232:235], v[116:119], v[56:59], v[232:235]
    v_add_u32 v19, s42, v19
    v_add_u32 v20, s42, v20
    v_mfma_f32_16x16x32_bf16 v[236:239], v[116:119], v[60:63], v[236:239]
    v_add_u32 v21, s42, v21
    s_add_u32 s41, s41, 1
    v_mfma_f32_16x16x32_bf16 v[240:243], v[48:51], v[120:123], v[240:243]
    v_mfma_f32_16x16x32_bf16 v[244:247], v[52:55], v[120:123], v[244:247]
    s_waitcnt lgkmcnt(0)
    s_barrier
    v_mfma_f32_16x16x32_bf16 v[248:251], v[56:59], v[120:123], v[248:251]
    v_mfma_f32_16x16x32_bf16 v[252:255], v[60:63], v[120:123], v[252:255]
    v_mfma_f32_16x16x32_bf16 v[208:211], v[128:131], v[64:67], v[208:211]
    ds_read_b128 v[48:51], v10 offset:0
    ds_read_b64_tr_b16 v[112:113], v19 offset:0
    v_mfma_f32_16x16x32_bf16 v[212:215], v[128:131], v[68:71], v[212:215]
    ds_read_b64_tr_b16 v[114:115], v19 offset:512
    ds_read_b128 v[52:55], v10 offset:2048
    v_mfma_f32_16x16x32_bf16 v[216:219], v[128:131], v[72:75], v[216:219]
    ds_read_b128 v[56:59], v10 offset:4096
    ds_read_b128 v[60:63], v10 offset:6144
    v_mfma_f32_16x16x32_bf16 v[220:223], v[128:131], v[76:79], v[220:223]
    ds_read_b64_tr_b16 v[116:117], v20 offset:0
    ds_read_b64_tr_b16 v[118:119], v20 offset:512
    v_mfma_f32_16x16x32_bf16 v[224:227], v[132:135], v[64:67], v[224:227]
    ds_read_b64_tr_b16 v[120:121], v21 offset:0
    ds_read_b64_tr_b16 v[122:123], v21 offset:512
    v_mfma_f32_16x16x32_bf16 v[228:231], v[132:135], v[68:71], v[228:231]
    s_and_b32 s40, s41, 3
    s_cmp_eq_u32 s40, 3
    v_mfma_f32_16x16x32_bf16 v[232:235], v[132:135], v[72:75], v[232:235]
    s_cselect_b32 s42, -73728, s89
    s_cmp_lt_u32 s41, 8
    v_mfma_f32_16x16x32_bf16 v[236:239], v[132:135], v[76:79], v[236:239]
    v_mfma_f32_16x16x32_bf16 v[240:243], v[64:67], v[136:139], v[240:243]
    v_mfma_f32_16x16x32_bf16 v[244:247], v[68:71], v[136:139], v[244:247]
    v_mfma_f32_16x16x32_bf16 v[248:251], v[72:75], v[136:139], v[248:251]
    s_waitcnt lgkmcnt(0)
    v_mfma_f32_16x16x32_bf16 v[252:255], v[76:79], v[136:139], v[252:255]
    s_cbranch_scc1 M_L1
    v_mfma_f32_16x16x32_bf16 v[208:211], v[112:115], v[48:51], v[208:211]
    ds_read_b128 v[64:67], v11 offset:0
    ds_read_b64_tr_b16 v[128:129], v19 offset:4096
    v_mfma_f32_16x16x32_bf16 v[212:215], v[112:115], v[52:55], v[212:215]
    ds_read_b64_tr_b16 v[130:131], v19 offset:4608
    ds_read_b128 v[68:71], v11 offset:2048
    v_mfma_f32_16x16x32_bf16 v[216:219], v[112:115], v[56:59], v[216:219]
    ds_read_b128 v[72:75], v11 offset:4096
    ds_read_b128 v[76:79], v11 offset:6144
    v_mfma_f32_16x16x32_bf16 v[220:223], v[112:115], v[60:63], v[220:223]
    ds_read_b64_tr_b16 v[132:133], v20 offset:4096
    ds_read_b64_tr_b16 v[134:135], v20 offset:4608
    v_mfma_f32_16x16x32_bf16 v[224:227], v[116:119], v[48:51], v[224:227]
    ds_read_b64_tr_b16 v[136:137], v21 offset:4096
    ds_read_b64_tr_b16 v[138:139], v21 offset:4608
    v_mfma_f32_16x16x32_bf16 v[228:231], v[116:119], v[52:55], v[228:231]
    s_add_u32 s41, s41, 1
    s_mov_b32 s47, 16
    v_mfma_f32_16x16x32_bf16 v[232:235], v[116:119], v[56:59], v[232:235]
    v_mfma_f32_16x16x32_bf16 v[236:239], v[116:119], v[60:63], v[236:239]
    v_mfma_f32_16x16x32_bf16 v[240:243], v[48:51], v[120:123], v[240:243]
    v_mfma_f32_16x16x32_bf16 v[244:247], v[52:55], v[120:123], v[244:247]
    v_mfma_f32_16x16x32_bf16 v[248:251], v[56:59], v[120:123], v[248:251]
    s_waitcnt lgkmcnt(0)
    v_mfma_f32_16x16x32_bf16 v[252:255], v[60:63], v[120:123], v[252:255]
    v_mfma_f32_16x16x32_bf16 v[208:211], v[128:131], v[64:67], v[208:211]
    v_mfma_f32_16x16x32_bf16 v[224:227], v[132:135], v[64:67], v[224:227]
    v_mfma_f32_16x16x32_bf16 v[212:215], v[128:131], v[68:71], v[212:215]
    v_mfma_f32_16x16x32_bf16 v[228:231], v[132:135], v[68:71], v[228:231]
    buffer_load_dword v47, v22, s[72:75], 0 offen sc1
    v_mfma_f32_16x16x32_bf16 v[216:219], v[128:131], v[72:75], v[216:219]
    v_mul_f32 v208, v7, v208
    v_mul_f32 v209, v7, v209
    v_mul_f32 v210, v7, v210
    v_mul_f32 v211, v7, v211
    v_mul_f32 v224, v7, v224
    v_mul_f32 v225, v7, v225
    v_mul_f32 v226, v7, v226
    v_mfma_f32_16x16x32_bf16 v[232:235], v[132:135], v[72:75], v[232:235]
    v_mul_f32 v227, v7, v227
    v_cvt_pk_bf16_f32 v208, v208, v209
    v_cvt_pk_bf16_f32 v209, v210, v211
    v_cvt_pk_bf16_f32 v210, v224, v225
    v_cvt_pk_bf16_f32 v211, v226, v227
    buffer_store_dwordx4 v[208:211], v2, s[16:19], 0 offen sc1
    v_mfma_f32_16x16x32_bf16 v[220:223], v[128:131], v[76:79], v[220:223]
    v_mul_f32 v212, v7, v212
    v_mul_f32 v213, v7, v213
    v_mul_f32 v214, v7, v214
    v_mul_f32 v215, v7, v215
    v_mul_f32 v228, v7, v228
    v_mul_f32 v229, v7, v229
    v_mul_f32 v230, v7, v230
    v_mfma_f32_16x16x32_bf16 v[236:239], v[132:135], v[76:79], v[236:239]
    v_mul_f32 v231, v7, v231
    v_cvt_pk_bf16_f32 v212, v212, v213
    v_cvt_pk_bf16_f32 v213, v214, v215
    v_cvt_pk_bf16_f32 v214, v228, v229
    v_cvt_pk_bf16_f32 v215, v230, v231
    buffer_store_dwordx4 v[212:215], v3, s[16:19], 0 offen sc1
    v_mfma_f32_16x16x32_bf16 v[240:243], v[64:67], v[136:139], v[240:243]
    v_mul_f32 v216, v7, v216
    v_mul_f32 v217, v7, v217
    v_mul_f32 v218, v7, v218
    v_mul_f32 v219, v7, v219
    v_mul_f32 v232, v7, v232
    v_mul_f32 v233, v7, v233
    v_mul_f32 v234, v7, v234
    v_mfma_f32_16x16x32_bf16 v[244:247], v[68:71], v[136:139], v[244:247]
    v_mul_f32 v235, v7, v235
    v_cvt_pk_bf16_f32 v216, v216, v217
    v_cvt_pk_bf16_f32 v217, v218, v219
    v_cvt_pk_bf16_f32 v218, v232, v233
    v_cvt_pk_bf16_f32 v219, v234, v235
    buffer_store_dwordx4 v[216:219], v4, s[16:19], 0 offen sc1
    v_mfma_f32_16x16x32_bf16 v[248:251], v[72:75], v[136:139], v[248:251]
    v_mul_f32 v220, v7, v220
    v_mul_f32 v221, v7, v221
    v_mul_f32 v222, v7, v222
    v_mul_f32 v223, v7, v223
    v_mul_f32 v236, v7, v236
    v_mul_f32 v237, v7, v237
    v_mul_f32 v238, v7, v238
    v_mfma_f32_16x16x32_bf16 v[252:255], v[76:79], v[136:139], v[252:255]
    v_mul_f32 v239, v7, v239
    v_cvt_pk_bf16_f32 v220, v220, v221
    v_cvt_pk_bf16_f32 v221, v222, v223
    v_cvt_pk_bf16_f32 v222, v236, v237
    v_cvt_pk_bf16_f32 v223, v238, v239
    buffer_store_dwordx4 v[220:223], v5, s[16:19], 0 offen sc1
    v_cvt_pk_bf16_f32 v240, v240, v241
    v_cvt_pk_bf16_f32 v241, v242, v243
    v_cvt_pk_bf16_f32 v242, v244, v245
    v_cvt_pk_bf16_f32 v243, v246, v247
    buffer_store_dwordx4 v[240:243], v6, s[16:19], 0 offen offset:1024 sc1
    s_nop 7
    v_cvt_pk_bf16_f32 v248, v248, v249
    v_cvt_pk_bf16_f32 v249, v250, v251
    v_cvt_pk_bf16_f32 v250, v252, v253
    v_cvt_pk_bf16_f32 v251, v254, v255
    buffer_store_dwordx4 v[248:251], v6, s[16:19], 0 offen offset:3072 sc1
    s_barrier
M_F:
    ds_read_b128 v[48:51], v17 offset:0
    ds_read_b64_tr_b16 v[112:113], v40 offset:0
    ds_read_b64_tr_b16 v[114:115], v40 offset:512
    ds_read_b128 v[52:55], v17 offset:2048
    ds_read_b128 v[56:59], v17 offset:4096
    ds_read_b128 v[60:63], v17 offset:6144
    ds_read_b64_tr_b16 v[116:117], v41 offset:0
    ds_read_b64_tr_b16 v[118:119], v41 offset:512
    ds_read_b64_tr_b16 v[120:121], v42 offset:0
    ds_read_b64_tr_b16 v[122:123], v42 offset:512
    ds_read_b64_tr_b16 v[124:125], v43 offset:0
    ds_read_b64_tr_b16 v[126:127], v43 offset:512
    s_and_b32 s40, s41, 3
    s_cmp_eq_u32 s40, 3
    s_cselect_b32 s42, -73728, s89
    s_cmp_eq_u32 s87, 0
    s_cselect_b32 s45, 0x2000, s42
    s_waitcnt lgkmcnt(0)
M_L2:
    v_mfma_f32_16x16x32_bf16 v[144:147], v[112:115], v[48:51], v[144:147]
    ds_read_b128 v[64:67], v18 offset:0
    ds_read_b64_tr_b16 v[128:129], v40 offset:4096
    v_mfma_f32_16x16x32_bf16 v[148:151], v[112:115], v[52:55], v[148:151]
    ds_read_b64_tr_b16 v[130:131], v40 offset:4608
    ds_read_b128 v[68:71], v18 offset:2048
    v_mfma_f32_16x16x32_bf16 v[152:155], v[112:115], v[56:59], v[152:155]
    ds_read_b128 v[72:75], v18 offset:4096
    ds_read_b128 v[76:79], v18 offset:6144
    v_mfma_f32_16x16x32_bf16 v[156:159], v[112:115], v[60:63], v[156:159]
    ds_read_b64_tr_b16 v[132:133], v41 offset:4096
    ds_read_b64_tr_b16 v[134:135], v41 offset:4608
    v_mfma_f32_16x16x32_bf16 v[160:163], v[116:119], v[48:51], v[160:163]
    ds_read_b64_tr_b16 v[136:137], v42 offset:4096
    ds_read_b64_tr_b16 v[138:139], v42 offset:4608
    v_mfma_f32_16x16x32_bf16 v[164:167], v[116:119], v[52:55], v[164:167]
    ds_read_b64_tr_b16 v[140:141], v43 offset:4096
    ds_read_b64_tr_b16 v[142:143], v43 offset:4608
    v_mfma_f32_16x16x32_bf16 v[168:171], v[116:119], v[56:59], v[168:171]
    v_add_u32 v17, s45, v17
    v_add_u32 v18, s45, v18
    v_mfma_f32_16x16x32_bf16 v[172:175], v[116:119], v[60:63], v[172:175]
    v_add_u32 v40, s42, v40
    v_add_u32 v41, s42, v41
    v_mfma_f32_16x16x32_bf16 v[176:179], v[120:123], v[48:51], v[176:179]
    v_add_u32 v42, s42, v42
    v_add_u32 v43, s42, v43
    v_mfma_f32_16x16x32_bf16 v[180:183], v[120:123], v[52:55], v[180:183]
    s_bitcmp1_b32 s46, s41
    v_mfma_f32_16x16x32_bf16 v[184:187], v[120:123], v[56:59], v[184:187]
    v_mfma_f32_16x16x32_bf16 v[188:191], v[120:123], v[60:63], v[188:191]
    v_mfma_f32_16x16x32_bf16 v[192:195], v[124:127], v[48:51], v[192:195]
    s_cbranch_scc1 M_P2
M_P2D:
    v_mfma_f32_16x16x32_bf16 v[196:199], v[124:127], v[52:55], v[196:199]
    s_waitcnt lgkmcnt(0)
    s_barrier
    v_mfma_f32_16x16x32_bf16 v[200:203], v[124:127], v[56:59], v[200:203]
    s_cmp_eq_u32 s41, 15
    v_mfma_f32_16x16x32_bf16 v[204:207], v[124:127], v[60:63], v[204:207]
    s_cbranch_scc1 M_LAST
    v_mfma_f32_16x16x32_bf16 v[144:147], v[128:131], v[64:67], v[144:147]
    ds_read_b128 v[48:51], v17 offset:0
    ds_read_b64_tr_b16 v[112:113], v40 offset:0
    v_mfma_f32_16x16x32_bf16 v[148:151], v[128:131], v[68:71], v[148:151]
    ds_read_b64_tr_b16 v[114:115], v40 offset:512
    ds_read_b128 v[52:55], v17 offset:2048
    v_mfma_f32_16x16x32_bf16 v[152:155], v[128:131], v[72:75], v[152:155]
    ds_read_b128 v[56:59], v17 offset:4096
    ds_read_b128 v[60:63], v17 offset:6144
    v_mfma_f32_16x16x32_bf16 v[156:159], v[128:131], v[76:79], v[156:159]
    ds_read_b64_tr_b16 v[116:117], v41 offset:0
    ds_read_b64_tr_b16 v[118:119], v41 offset:512
    v_mfma_f32_16x16x32_bf16 v[160:163], v[132:135], v[64:67], v[160:163]
    ds_read_b64_tr_b16 v[120:121], v42 offset:0
    ds_read_b64_tr_b16 v[122:123], v42 offset:512
    v_mfma_f32_16x16x32_bf16 v[164:167], v[132:135], v[68:71], v[164:167]
    ds_read_b64_tr_b16 v[124:125], v43 offset:0
    ds_read_b64_tr_b16 v[126:127], v43 offset:512
    v_mfma_f32_16x16x32_bf16 v[168:171], v[132:135], v[72:75], v[168:171]
    s_add_u32 s41, s41, 1
    s_and_b32 s40, s41, 3
    v_mfma_f32_16x16x32_bf16 v[172:175], v[132:135], v[76:79], v[172:175]
    s_cmp_eq_u32 s40, 3
    s_cselect_b32 s42, -73728, s89
    v_mfma_f32_16x16x32_bf16 v[176:179], v[136:139], v[64:67], v[176:179]
    s_cmp_eq_u32 s87, 0
    s_cselect_b32 s45, 0x2000, s42
    v_mfma_f32_16x16x32_bf16 v[180:183], v[136:139], v[68:71], v[180:183]
    s_cmp_lt_u32 s41, s47
    v_mfma_f32_16x16x32_bf16 v[184:187], v[136:139], v[72:75], v[184:187]
    v_mfma_f32_16x16x32_bf16 v[188:191], v[136:139], v[76:79], v[188:191]
    v_mfma_f32_16x16x32_bf16 v[192:195], v[140:143], v[64:67], v[192:195]
    v_mfma_f32_16x16x32_bf16 v[196:199], v[140:143], v[68:71], v[196:199]
    v_mfma_f32_16x16x32_bf16 v[200:203], v[140:143], v[72:75], v[200:203]
    s_waitcnt lgkmcnt(0)
    v_mfma_f32_16x16x32_bf16 v[204:207], v[140:143], v[76:79], v[204:207]
    s_cbranch_scc1 M_L2
    s_branch M_Q
M_LAST:
    v_mfma_f32_16x16x32_bf16 v[144:147], v[128:131], v[64:67], v[144:147]
    s_mov_b32 s52, 0x0000ffff
    s_mov_b32 s53, 0x0000ffff
    s_mov_b32 s54, 0
    v_mfma_f32_16x16x32_bf16 v[160:163], v[132:135], v[64:67], v[160:163]
    s_lshl_b32 s40, s36, 2
    s_add_u32 s40, s40, 135216
    v_mov_b32 v6, s40
    v_mfma_f32_16x16x32_bf16 v[148:151], v[128:131], v[68:71], v[148:151]
    v_mov_b32 v7, 1
    v_mov_b32 v5, 135168
    v_mov_b32 v2, v1
    v_mfma_f32_16x16x32_bf16 v[164:167], v[132:135], v[68:71], v[164:167]
    s_lshl_b32 s40, s94, 1
    s_add_u32 s40, s40, s88
    s_nop 0
    v_mfma_f32_16x16x32_bf16 v[152:155], v[128:131], v[72:75], v[152:155]
    v_mul_f32 v224, 0x3fb8aa3b, v144
    v_cvt_pk_bf16_f32 v144, v144, v145
    v_cvt_pk_bf16_f32 v145, v146, v147
    v_cvt_pk_bf16_f32 v146, v160, v161
    v_cvt_pk_bf16_f32 v147, v162, v163
    v_mfma_f32_16x16x32_bf16 v[168:171], v[132:135], v[72:75], v[168:171]
    v_pk_max_i16 v144, v144, 0
    v_pk_max_i16 v145, v145, 0
    v_pk_max_i16 v146, v146, 0
    v_pk_max_i16 v147, v147, 0
    ds_write_b128 v44, v[144:147] offset:0
    v_mfma_f32_16x16x32_bf16 v[156:159], v[128:131], v[76:79], v[156:159]
    v_mul_f32 v225, 0x3fb8aa3b, v148
    v_cvt_pk_bf16_f32 v148, v148, v149
    v_cvt_pk_bf16_f32 v149, v150, v151
    v_cvt_pk_bf16_f32 v150, v164, v165
    v_cvt_pk_bf16_f32 v151, v166, v167
    v_mfma_f32_16x16x32_bf16 v[172:175], v[132:135], v[76:79], v[172:175]
    v_pk_max_i16 v148, v148, 0
    v_pk_max_i16 v149, v149, 0
    v_pk_max_i16 v150, v150, 0
    v_pk_max_i16 v151, v151, 0
    ds_write_b128 v44, v[148:151] offset:256
    v_mfma_f32_16x16x32_bf16 v[176:179], v[136:139], v[64:67], v[176:179]
    v_mul_f32 v226, 0x3fb8aa3b, v152
    v_cvt_pk_bf16_f32 v152, v152, v153
    v_cvt_pk_bf16_f32 v153, v154, v155
    v_cvt_pk_bf16_f32 v154, v168, v169
    v_cvt_pk_bf16_f32 v155, v170, v171
    v_mfma_f32_16x16x32_bf16 v[192:195], v[140:143], v[64:67], v[192:195]
    v_pk_max_i16 v152, v152, 0
    v_pk_max_i16 v153, v153, 0
    v_pk_max_i16 v154, v154, 0
    v_pk_max_i16 v155, v155, 0
    ds_write_b128 v44, v[152:155] offset:16384
    v_mfma_f32_16x16x32_bf16 v[180:183], v[136:139], v[68:71], v[180:183]
    v_mul_f32 v227, 0x3fb8aa3b, v156
    v_cvt_pk_bf16_f32 v156, v156, v157
    v_cvt_pk_bf16_f32 v157, v158, v159
    v_cvt_pk_bf16_f32 v158, v172, v173
    v_cvt_pk_bf16_f32 v159, v174, v175
    v_mfma_f32_16x16x32_bf16 v[196:199], v[140:143], v[68:71], v[196:199]
    v_pk_max_i16 v156, v156, 0
    v_pk_max_i16 v157, v157, 0
    v_pk_max_i16 v158, v158, 0
    v_pk_max_i16 v159, v159, 0
    ds_write_b128 v44, v[156:159] offset:16640
    v_mfma_f32_16x16x32_bf16 v[184:187], v[136:139], v[72:75], v[184:187]
    v_cvt_pk_bf16_f32 v176, v176, v177
    v_cvt_pk_bf16_f32 v177, v178, v179
    v_cvt_pk_bf16_f32 v178, v192, v193
    v_cvt_pk_bf16_f32 v179, v194, v195
    v_pk_max_i16 v176, v176, 0
    v_mfma_f32_16x16x32_bf16 v[200:203], v[140:143], v[72:75], v[200:203]
    v_pk_max_i16 v177, v177, 0
    v_pk_max_i16 v178, v178, 0
    v_pk_max_i16 v179, v179, 0
    ds_write_b128 v44, v[176:179] offset:2048
    v_mfma_f32_16x16x32_bf16 v[188:191], v[136:139], v[76:79], v[188:191]
    v_cvt_pk_bf16_f32 v180, v180, v181
    v_cvt_pk_bf16_f32 v181, v182, v183
    v_cvt_pk_bf16_f32 v182, v196, v197
    v_cvt_pk_bf16_f32 v183, v198, v199
    v_pk_max_i16 v180, v180, 0
    v_mfma_f32_16x16x32_bf16 v[204:207], v[140:143], v[76:79], v[204:207]
    v_pk_max_i16 v181, v181, 0
    v_pk_max_i16 v182, v182, 0
    v_pk_max_i16 v183, v183, 0
    ds_write_b128 v44, v[180:183] offset:2304
    s_nop 3
    v_cvt_pk_bf16_f32 v184, v184, v185
    v_cvt_pk_bf16_f32 v185, v186, v187
    v_cvt_pk_bf16_f32 v186, v200, v201
    v_cvt_pk_bf16_f32 v187, v202, v203
    v_pk_max_i16 v184, v184, 0
    v_pk_max_i16 v185, v185, 0
    v_pk_max_i16 v186, v186, 0
    v_pk_max_i16 v187, v187, 0
    ds_write_b128 v44, v[184:187] offset:18432
    v_cvt_pk_bf16_f32 v188, v188, v189
    v_cvt_pk_bf16_f32 v189, v190, v191
    v_cvt_pk_bf16_f32 v190, v204, v205
    v_cvt_pk_bf16_f32 v191, v206, v207
    v_pk_max_i16 v188, v188, 0
    v_pk_max_i16 v189, v189, 0
    v_pk_max_i16 v190, v190, 0
    v_pk_max_i16 v191, v191, 0
    ds_write_b128 v44, v[188:191] offset:18688
    s_cmp_lg_u32 s40, 28
    s_cbranch_scc1 M_HD
    v_mov_b32 v228, 0x42ac0000
    v_cmp_gt_f32 vcc, v224, v228
    s_nop 1
    v_cndmask_b32 v224, v224, v228, vcc
    v_cmp_gt_f32 vcc, v225, v228
    s_nop 1
    v_cndmask_b32 v225, v225, v228, vcc
    v_cmp_gt_f32 vcc, v226, v228
    s_nop 1
    v_cndmask_b32 v226, v226, v228, vcc
    v_cmp_gt_f32 vcc, v227, v228
    s_nop 1
    v_cndmask_b32 v227, v227, v228, vcc
    v_exp_f32 v224, v224
    v_exp_f32 v225, v225
    v_exp_f32 v226, v226
    v_exp_f32 v227, v227
    s_mov_b64 exec, 0xffff
    ds_write_b32 v45, v224 offset:0
    ds_write_b32 v45, v225 offset:64
    ds_write_b32 v45, v226 offset:128
    ds_write_b32 v45, v227 offset:192
    s_mov_b64 exec, -1
M_HD:
    ds_write_b32 v6, v7
    s_mov_b32 s43, 0
M_QW:
    s_cmp_lg_u32 s84, 0
    s_cbranch_scc1 M_QWD
    s_waitcnt vmcnt(0)
    v_cmp_eq_u32 vcc, v47, v23
    s_add_u32 s43, s43, 1
    s_cmp_ge_u32 s43, 65536
    s_cselect_b32 s84, 1, vcc_lo
    s_cmp_lg_u32 s84, 0
    s_cbranch_scc1 M_QL
    buffer_load_dword v23, v22, s[16:19], s85 offen sc1
    s_branch M_QW
M_QL:
    buffer_load_dwordx4 v[8:11], v1, s[16:19], s86 offen sc1
    buffer_load_dwordx4 v[12:15], v1, s[16:19], s86 offen offset:1024 sc1
M_QWD:
M_QW2:
    ds_read_b32 v4, v5
    s_waitcnt lgkmcnt(0)
    v_readfirstlane_b32 s40, v4
    s_cmp_ge_u32 s40, 4
    s_cbranch_scc1 M_S0
    s_sleep 1
    s_branch M_QW2
M_S0:
    ds_read_b128 v[16:19], v2 offset:0
    s_mov_b64 exec, s[52:53]
    ds_read_b128 v[24:27], v2 offset:1024
    ds_read_b128 v[28:31], v2 offset:1280
    s_mov_b64 exec, -1
    ds_read_b128 v[20:23], v2 offset:2048
    v_mov_b32 v5, 135172
    s_mov_b32 s59, 0x07060302
    v_and_b32 v3, 31, v0
    s_lshl_b32 s40, s36, 8
    s_add_u32 s40, s40, 161792
    v_lshl_add_u32 v3, v3, 2, s40
    v_mov_b32 v44, 0
    v_mov_b32 v45, 0
    v_mov_b32 v46, 0
    v_mov_b32 v47, 0
    s_waitcnt vmcnt(0) lgkmcnt(3)
    v_mfma_f32_32x32x16_bf16 v[48:63], v[16:19], v[8:11], 0
    s_mov_b32 s55, 0
    s_nop 7
    s_nop 3
M_BLOOP:
    v_exp_f32 v48, v48
    v_exp_f32 v49, v49
    v_exp_f32 v50, v50
    v_exp_f32 v51, v51
    v_mfma_f32_32x32x16_bf16 v[96:111], v[36:39], v[44:47], v[96:111]
    s_waitcnt lgkmcnt(0)
    v_exp_f32 v52, v52
    v_exp_f32 v53, v53
    v_exp_f32 v54, v54
    v_exp_f32 v55, v55
    v_cvt_pk_bf16_f32 v40, v48, v49
    v_cvt_pk_bf16_f32 v41, v50, v51
    v_mfma_f32_32x32x16_bf16 v[64:79], v[16:19], v[12:15], 0
    s_mov_b64 exec, s[52:53]
    ds_read_b128 v[32:35], v2 offset:3072
    ds_read_b128 v[36:39], v2 offset:3328
    s_mov_b64 exec, -1
    v_exp_f32 v56, v56
    v_cvt_pk_bf16_f32 v42, v52, v53
    v_cvt_pk_bf16_f32 v43, v54, v55
    v_exp_f32 v57, v57
    v_exp_f32 v58, v58
    v_exp_f32 v59, v59
    v_exp_f32 v60, v60
    v_mfma_f32_32x32x16_bf16 v[80:95], v[24:27], v[40:43], v[80:95]
    ds_read_b128 v[16:19], v2 offset:4096
    v_exp_f32 v61, v61
    v_exp_f32 v62, v62
    v_exp_f32 v63, v63
    v_cvt_pk_bf16_f32 v44, v56, v57
    v_cvt_pk_bf16_f32 v45, v58, v59
    v_cvt_pk_bf16_f32 v46, v60, v61
    v_cvt_pk_bf16_f32 v47, v62, v63
    v_exp_f32 v64, v64
    v_exp_f32 v65, v65
    v_exp_f32 v66, v66
    v_exp_f32 v67, v67
    v_mfma_f32_32x32x16_bf16 v[80:95], v[28:31], v[44:47], v[80:95]
    v_exp_f32 v68, v68
    v_exp_f32 v69, v69
    v_exp_f32 v70, v70
    v_exp_f32 v71, v71
    v_cvt_pk_bf16_f32 v40, v64, v65
    v_cvt_pk_bf16_f32 v41, v66, v67
    v_mfma_f32_32x32x16_bf16 v[48:63], v[20:23], v[8:11], 0
    v_exp_f32 v72, v72
    v_cvt_pk_bf16_f32 v42, v68, v69
    v_cvt_pk_bf16_f32 v43, v70, v71
    v_exp_f32 v73, v73
    v_exp_f32 v74, v74
    v_exp_f32 v75, v75
    v_exp_f32 v76, v76
    v_mfma_f32_32x32x16_bf16 v[96:111], v[24:27], v[40:43], v[96:111]
    v_exp_f32 v77, v77
    v_exp_f32 v78, v78
    v_exp_f32 v79, v79
    v_cvt_pk_bf16_f32 v44, v72, v73
    v_cvt_pk_bf16_f32 v45, v74, v75
    v_cvt_pk_bf16_f32 v46, v76, v77
    v_cvt_pk_bf16_f32 v47, v78, v79
    v_exp_f32 v48, v48
    v_exp_f32 v49, v49
    v_exp_f32 v50, v50
    v_exp_f32 v51, v51
    v_mfma_f32_32x32x16_bf16 v[96:111], v[28:31], v[44:47], v[96:111]
    s_waitcnt lgkmcnt(0)
    v_exp_f32 v52, v52
    v_exp_f32 v53, v53
    v_exp_f32 v54, v54
    v_exp_f32 v55, v55
    v_cvt_pk_bf16_f32 v40, v48, v49
    v_cvt_pk_bf16_f32 v41, v50, v51
    v_mfma_f32_32x32x16_bf16 v[64:79], v[20:23], v[12:15], 0
    s_mov_b64 exec, s[52:53]
    ds_read_b128 v[24:27], v2 offset:5120
    ds_read_b128 v[28:31], v2 offset:5376
    s_mov_b64 exec, -1
    v_exp_f32 v56, v56
    v_cvt_pk_bf16_f32 v42, v52, v53
    v_cvt_pk_bf16_f32 v43, v54, v55
    v_exp_f32 v57, v57
    v_exp_f32 v58, v58
    v_exp_f32 v59, v59
    v_exp_f32 v60, v60
    v_mfma_f32_32x32x16_bf16 v[80:95], v[32:35], v[40:43], v[80:95]
    ds_read_b128 v[20:23], v2 offset:6144
    v_exp_f32 v61, v61
    v_exp_f32 v62, v62
    v_exp_f32 v63, v63
    v_cvt_pk_bf16_f32 v44, v56, v57
    v_cvt_pk_bf16_f32 v45, v58, v59
    v_cvt_pk_bf16_f32 v46, v60, v61
    v_cvt_pk_bf16_f32 v47, v62, v63
    v_exp_f32 v64, v64
    v_exp_f32 v65, v65
    v_exp_f32 v66, v66
    v_exp_f32 v67, v67
    v_mfma_f32_32x32x16_bf16 v[80:95], v[36:39], v[44:47], v[80:95]
    v_exp_f32 v68, v68
    v_exp_f32 v69, v69
    v_exp_f32 v70, v70
    v_exp_f32 v71, v71
    v_cvt_pk_bf16_f32 v40, v64, v65
    v_cvt_pk_bf16_f32 v41, v66, v67
    v_mfma_f32_32x32x16_bf16 v[48:63], v[16:19], v[8:11], 0
    v_exp_f32 v72, v72
    v_cvt_pk_bf16_f32 v42, v68, v69
    v_cvt_pk_bf16_f32 v43, v70, v71
    v_exp_f32 v73, v73
    v_exp_f32 v74, v74
    v_exp_f32 v75, v75
    v_exp_f32 v76, v76
    v_mfma_f32_32x32x16_bf16 v[96:111], v[32:35], v[40:43], v[96:111]
    v_exp_f32 v77, v77
    v_exp_f32 v78, v78
    v_exp_f32 v79, v79
    v_cvt_pk_bf16_f32 v44, v72, v73
    v_cvt_pk_bf16_f32 v45, v74, v75
    v_cvt_pk_bf16_f32 v46, v76, v77
    v_cvt_pk_bf16_f32 v47, v78, v79
    v_exp_f32 v48, v48
    v_exp_f32 v49, v49
    v_exp_f32 v50, v50
    v_exp_f32 v51, v51
    v_mfma_f32_32x32x16_bf16 v[96:111], v[36:39], v[44:47], v[96:111]
    s_waitcnt lgkmcnt(0)
    v_exp_f32 v52, v52
    v_exp_f32 v53, v53
    v_exp_f32 v54, v54
    v_exp_f32 v55, v55
    v_cvt_pk_bf16_f32 v40, v48, v49
    v_cvt_pk_bf16_f32 v41, v50, v51
    v_mfma_f32_32x32x16_bf16 v[64:79], v[16:19], v[12:15], 0
    s_mov_b64 exec, s[52:53]
    ds_read_b128 v[32:35], v2 offset:7168
    ds_read_b128 v[36:39], v2 offset:7424
    s_mov_b64 exec, -1
    v_exp_f32 v56, v56
    v_cvt_pk_bf16_f32 v42, v52, v53
    v_cvt_pk_bf16_f32 v43, v54, v55
    v_exp_f32 v57, v57
    v_exp_f32 v58, v58
    v_exp_f32 v59, v59
    v_exp_f32 v60, v60
    v_mfma_f32_32x32x16_bf16 v[80:95], v[24:27], v[40:43], v[80:95]
    ds_read_b128 v[16:19], v2 offset:8192
    v_exp_f32 v61, v61
    v_exp_f32 v62, v62
    v_exp_f32 v63, v63
    v_cvt_pk_bf16_f32 v44, v56, v57
    v_cvt_pk_bf16_f32 v45, v58, v59
    v_cvt_pk_bf16_f32 v46, v60, v61
    v_cvt_pk_bf16_f32 v47, v62, v63
    v_exp_f32 v64, v64
    v_exp_f32 v65, v65
    v_exp_f32 v66, v66
    v_exp_f32 v67, v67
    v_mfma_f32_32x32x16_bf16 v[80:95], v[28:31], v[44:47], v[80:95]
    v_exp_f32 v68, v68
    v_exp_f32 v69, v69
    v_exp_f32 v70, v70
    v_exp_f32 v71, v71
    v_cvt_pk_bf16_f32 v40, v64, v65
    v_cvt_pk_bf16_f32 v41, v66, v67
    v_mfma_f32_32x32x16_bf16 v[48:63], v[20:23], v[8:11], 0
    v_exp_f32 v72, v72
    v_cvt_pk_bf16_f32 v42, v68, v69
    v_cvt_pk_bf16_f32 v43, v70, v71
    v_exp_f32 v73, v73
    v_exp_f32 v74, v74
    v_exp_f32 v75, v75
    v_exp_f32 v76, v76
    v_mfma_f32_32x32x16_bf16 v[96:111], v[24:27], v[40:43], v[96:111]
    v_exp_f32 v77, v77
    v_exp_f32 v78, v78
    v_exp_f32 v79, v79
    v_cvt_pk_bf16_f32 v44, v72, v73
    v_cvt_pk_bf16_f32 v45, v74, v75
    v_cvt_pk_bf16_f32 v46, v76, v77
    v_cvt_pk_bf16_f32 v47, v78, v79
    v_exp_f32 v48, v48
    v_exp_f32 v49, v49
    v_exp_f32 v50, v50
    v_exp_f32 v51, v51
    v_mfma_f32_32x32x16_bf16 v[96:111], v[28:31], v[44:47], v[96:111]
    s_waitcnt lgkmcnt(0)
    v_exp_f32 v52, v52
    v_exp_f32 v53, v53
    v_exp_f32 v54, v54
    v_exp_f32 v55, v55
    v_cvt_pk_bf16_f32 v40, v48, v49
    v_cvt_pk_bf16_f32 v41, v50, v51
    v_mfma_f32_32x32x16_bf16 v[64:79], v[20:23], v[12:15], 0
    s_mov_b64 exec, s[52:53]
    ds_read_b128 v[24:27], v2 offset:9216
    ds_read_b128 v[28:31], v2 offset:9472
    s_mov_b64 exec, -1
    v_exp_f32 v56, v56
    v_cvt_pk_bf16_f32 v42, v52, v53
    v_cvt_pk_bf16_f32 v43, v54, v55
    v_exp_f32 v57, v57
    v_exp_f32 v58, v58
    v_exp_f32 v59, v59
    v_exp_f32 v60, v60
    v_mfma_f32_32x32x16_bf16 v[80:95], v[32:35], v[40:43], v[80:95]
    ds_read_b128 v[20:23], v2 offset:10240
    v_exp_f32 v61, v61
    v_exp_f32 v62, v62
    v_exp_f32 v63, v63
    v_cvt_pk_bf16_f32 v44, v56, v57
    v_cvt_pk_bf16_f32 v45, v58, v59
    v_cvt_pk_bf16_f32 v46, v60, v61
    v_cvt_pk_bf16_f32 v47, v62, v63
    v_exp_f32 v64, v64
    v_exp_f32 v65, v65
    v_exp_f32 v66, v66
    v_exp_f32 v67, v67
    v_mfma_f32_32x32x16_bf16 v[80:95], v[36:39], v[44:47], v[80:95]
    v_exp_f32 v68, v68
    v_exp_f32 v69, v69
    v_exp_f32 v70, v70
    v_exp_f32 v71, v71
    v_cvt_pk_bf16_f32 v40, v64, v65
    v_cvt_pk_bf16_f32 v41, v66, v67
    v_mfma_f32_32x32x16_bf16 v[48:63], v[16:19], v[8:11], 0
    v_exp_f32 v72, v72
    v_cvt_pk_bf16_f32 v42, v68, v69
    v_cvt_pk_bf16_f32 v43, v70, v71
    v_exp_f32 v73, v73
    v_exp_f32 v74, v74
    v_exp_f32 v75, v75
    v_exp_f32 v76, v76
    v_mfma_f32_32x32x16_bf16 v[96:111], v[32:35], v[40:43], v[96:111]
    v_exp_f32 v77, v77
    v_exp_f32 v78, v78
    v_exp_f32 v79, v79
    v_cvt_pk_bf16_f32 v44, v72, v73
    v_cvt_pk_bf16_f32 v45, v74, v75
    v_cvt_pk_bf16_f32 v46, v76, v77
    v_cvt_pk_bf16_f32 v47, v78, v79
    v_exp_f32 v48, v48
    v_exp_f32 v49, v49
    v_exp_f32 v50, v50
    v_exp_f32 v51, v51
    v_mfma_f32_32x32x16_bf16 v[96:111], v[36:39], v[44:47], v[96:111]
    s_waitcnt lgkmcnt(0)
    v_exp_f32 v52, v52
    v_exp_f32 v53, v53
    v_exp_f32 v54, v54
    v_exp_f32 v55, v55
    v_cvt_pk_bf16_f32 v40, v48, v49
    v_cvt_pk_bf16_f32 v41, v50, v51
    v_mfma_f32_32x32x16_bf16 v[64:79], v[16:19], v[12:15], 0
    s_mov_b64 exec, s[52:53]
    ds_read_b128 v[32:35], v2 offset:11264
    ds_read_b128 v[36:39], v2 offset:11520
    s_mov_b64 exec, -1
    v_exp_f32 v56, v56
    v_cvt_pk_bf16_f32 v42, v52, v53
    v_cvt_pk_bf16_f32 v43, v54, v55
    v_exp_f32 v57, v57
    v_exp_f32 v58, v58
    v_exp_f32 v59, v59
    v_exp_f32 v60, v60
    v_mfma_f32_32x32x16_bf16 v[80:95], v[24:27], v[40:43], v[80:95]
    ds_read_b128 v[16:19], v2 offset:12288
    ds_read_b32 v4, v5
    v_exp_f32 v61, v61
    v_exp_f32 v62, v62
    v_exp_f32 v63, v63
    v_cvt_pk_bf16_f32 v44, v56, v57
    v_cvt_pk_bf16_f32 v45, v58, v59
    v_cvt_pk_bf16_f32 v46, v60, v61
    v_cvt_pk_bf16_f32 v47, v62, v63
    v_exp_f32 v64, v64
    v_exp_f32 v65, v65
    v_exp_f32 v66, v66
    v_exp_f32 v67, v67
    v_mfma_f32_32x32x16_bf16 v[80:95], v[28:31], v[44:47], v[80:95]
    v_exp_f32 v68, v68
    v_exp_f32 v69, v69
    v_exp_f32 v70, v70
    v_exp_f32 v71, v71
    v_cvt_pk_bf16_f32 v40, v64, v65
    v_cvt_pk_bf16_f32 v41, v66, v67
    v_mfma_f32_32x32x16_bf16 v[48:63], v[20:23], v[8:11], 0
    v_exp_f32 v72, v72
    v_cvt_pk_bf16_f32 v42, v68, v69
    v_cvt_pk_bf16_f32 v43, v70, v71
    v_exp_f32 v73, v73
    v_exp_f32 v74, v74
    v_exp_f32 v75, v75
    v_exp_f32 v76, v76
    v_mfma_f32_32x32x16_bf16 v[96:111], v[24:27], v[40:43], v[96:111]
    v_exp_f32 v77, v77
    v_exp_f32 v78, v78
    v_exp_f32 v79, v79
    v_cvt_pk_bf16_f32 v44, v72, v73
    v_cvt_pk_bf16_f32 v45, v74, v75
    v_cvt_pk_bf16_f32 v46, v76, v77
    v_cvt_pk_bf16_f32 v47, v78, v79
    v_exp_f32 v48, v48
    v_exp_f32 v49, v49
    v_exp_f32 v50, v50
    v_exp_f32 v51, v51
    v_mfma_f32_32x32x16_bf16 v[96:111], v[28:31], v[44:47], v[96:111]
    s_waitcnt lgkmcnt(0)
    v_exp_f32 v52, v52
    v_exp_f32 v53, v53
    v_exp_f32 v54, v54
    v_exp_f32 v55, v55
    v_cvt_pk_bf16_f32 v40, v48, v49
    v_cvt_pk_bf16_f32 v41, v50, v51
    v_readfirstlane_b32 s40, v4
    v_mfma_f32_32x32x16_bf16 v[64:79], v[20:23], v[12:15], 0
    s_mov_b64 exec, s[52:53]
    ds_read_b128 v[24:27], v2 offset:13312
    ds_read_b128 v[28:31], v2 offset:13568
    s_mov_b64 exec, -1
    v_exp_f32 v56, v56
    v_cvt_pk_bf16_f32 v42, v52, v53
    v_cvt_pk_bf16_f32 v43, v54, v55
    v_exp_f32 v57, v57
    v_exp_f32 v58, v58
    v_exp_f32 v59, v59
    v_exp_f32 v60, v60
    v_mfma_f32_32x32x16_bf16 v[80:95], v[32:35], v[40:43], v[80:95]
    ds_read_b128 v[20:23], v2 offset:14336
    v_exp_f32 v61, v61
    v_exp_f32 v62, v62
    v_exp_f32 v63, v63
    v_cvt_pk_bf16_f32 v44, v56, v57
    v_cvt_pk_bf16_f32 v45, v58, v59
    v_cvt_pk_bf16_f32 v46, v60, v61
    v_cvt_pk_bf16_f32 v47, v62, v63
    v_exp_f32 v64, v64
    v_exp_f32 v65, v65
    v_exp_f32 v66, v66
    v_exp_f32 v67, v67
    v_mfma_f32_32x32x16_bf16 v[80:95], v[36:39], v[44:47], v[80:95]
    s_cmp_lt_u32 s40, 4
    v_exp_f32 v68, v68
    v_exp_f32 v69, v69
    v_exp_f32 v70, v70
    v_exp_f32 v71, v71
    v_cvt_pk_bf16_f32 v40, v64, v65
    v_cvt_pk_bf16_f32 v41, v66, v67
    v_mfma_f32_32x32x16_bf16 v[48:63], v[16:19], v[8:11], 0
    s_cbranch_scc1 M_SPIN
M_SPIND:
    v_exp_f32 v72, v72
    v_cvt_pk_bf16_f32 v42, v68, v69
    v_cvt_pk_bf16_f32 v43, v70, v71
    v_exp_f32 v73, v73
    v_exp_f32 v74, v74
    v_exp_f32 v75, v75
    v_exp_f32 v76, v76
    v_mfma_f32_32x32x16_bf16 v[96:111], v[32:35], v[40:43], v[96:111]
    v_exp_f32 v77, v77
    v_exp_f32 v78, v78
    v_exp_f32 v79, v79
    v_cvt_pk_bf16_f32 v44, v72, v73
    v_cvt_pk_bf16_f32 v45, v74, v75
    v_cvt_pk_bf16_f32 v46, v76, v77
    v_cvt_pk_bf16_f32 v47, v78, v79
    v_exp_f32 v48, v48
    v_exp_f32 v49, v49
    v_exp_f32 v50, v50
    v_exp_f32 v51, v51
    v_mfma_f32_32x32x16_bf16 v[96:111], v[36:39], v[44:47], v[96:111]
    s_waitcnt lgkmcnt(0)
    v_exp_f32 v52, v52
    v_exp_f32 v53, v53
    v_exp_f32 v54, v54
    v_exp_f32 v55, v55
    v_cvt_pk_bf16_f32 v40, v48, v49
    v_cvt_pk_bf16_f32 v41, v50, v51
    v_mfma_f32_32x32x16_bf16 v[64:79], v[16:19], v[12:15], 0
    s_mov_b64 exec, s[52:53]
    ds_read_b128 v[32:35], v2 offset:15360
    ds_read_b128 v[36:39], v2 offset:15616
    s_mov_b64 exec, -1
    v_exp_f32 v56, v56
    v_cvt_pk_bf16_f32 v42, v52, v53
    v_cvt_pk_bf16_f32 v43, v54, v55
    v_exp_f32 v57, v57
    v_exp_f32 v58, v58
    v_exp_f32 v59, v59
    v_exp_f32 v60, v60
    v_mfma_f32_32x32x16_bf16 v[80:95], v[24:27], v[40:43], v[80:95]
    ds_read_b128 v[16:19], v2 offset:16384
    v_exp_f32 v61, v61
    v_exp_f32 v62, v62
    v_exp_f32 v63, v63
    v_cvt_pk_bf16_f32 v44, v56, v57
    v_cvt_pk_bf16_f32 v45, v58, v59
    v_cvt_pk_bf16_f32 v46, v60, v61
    v_cvt_pk_bf16_f32 v47, v62, v63
    v_exp_f32 v64, v64
    v_exp_f32 v65, v65
    v_exp_f32 v66, v66
    v_exp_f32 v67, v67
    v_mfma_f32_32x32x16_bf16 v[80:95], v[28:31], v[44:47], v[80:95]
    v_exp_f32 v68, v68
    v_exp_f32 v69, v69
    v_exp_f32 v70, v70
    v_exp_f32 v71, v71
    v_cvt_pk_bf16_f32 v40, v64, v65
    v_cvt_pk_bf16_f32 v41, v66, v67
    v_mfma_f32_32x32x16_bf16 v[48:63], v[20:23], v[8:11], 0
    v_exp_f32 v72, v72
    v_cvt_pk_bf16_f32 v42, v68, v69
    v_cvt_pk_bf16_f32 v43, v70, v71
    v_exp_f32 v73, v73
    v_exp_f32 v74, v74
    v_exp_f32 v75, v75
    v_exp_f32 v76, v76
    v_mfma_f32_32x32x16_bf16 v[96:111], v[24:27], v[40:43], v[96:111]
    v_exp_f32 v77, v77
    v_exp_f32 v78, v78
    v_exp_f32 v79, v79
    v_cvt_pk_bf16_f32 v44, v72, v73
    v_cvt_pk_bf16_f32 v45, v74, v75
    v_cvt_pk_bf16_f32 v46, v76, v77
    v_cvt_pk_bf16_f32 v47, v78, v79
    v_exp_f32 v48, v48
    v_exp_f32 v49, v49
    v_exp_f32 v50, v50
    v_exp_f32 v51, v51
    v_mfma_f32_32x32x16_bf16 v[96:111], v[28:31], v[44:47], v[96:111]
    s_waitcnt lgkmcnt(0)
    v_exp_f32 v52, v52
    v_exp_f32 v53, v53
    v_exp_f32 v54, v54
    v_exp_f32 v55, v55
    v_cvt_pk_bf16_f32 v40, v48, v49
    v_cvt_pk_bf16_f32 v41, v50, v51
    v_mfma_f32_32x32x16_bf16 v[64:79], v[20:23], v[12:15], 0
    s_mov_b64 exec, s[52:53]
    ds_read_b128 v[24:27], v2 offset:17408
    ds_read_b128 v[28:31], v2 offset:17664
    s_mov_b64 exec, -1
    v_exp_f32 v56, v56
    v_cvt_pk_bf16_f32 v42, v52, v53
    v_cvt_pk_bf16_f32 v43, v54, v55
    v_exp_f32 v57, v57
    v_exp_f32 v58, v58
    v_exp_f32 v59, v59
    v_exp_f32 v60, v60
    v_mfma_f32_32x32x16_bf16 v[80:95], v[32:35], v[40:43], v[80:95]
    ds_read_b128 v[20:23], v2 offset:18432
    v_exp_f32 v61, v61
    v_exp_f32 v62, v62
    v_exp_f32 v63, v63
    v_cvt_pk_bf16_f32 v44, v56, v57
    v_cvt_pk_bf16_f32 v45, v58, v59
    v_cvt_pk_bf16_f32 v46, v60, v61
    v_cvt_pk_bf16_f32 v47, v62, v63
    v_exp_f32 v64, v64
    v_exp_f32 v65, v65
    v_exp_f32 v66, v66
    v_exp_f32 v67, v67
    v_mfma_f32_32x32x16_bf16 v[80:95], v[36:39], v[44:47], v[80:95]
    v_exp_f32 v68, v68
    v_exp_f32 v69, v69
    v_exp_f32 v70, v70
    v_exp_f32 v71, v71
    v_cvt_pk_bf16_f32 v40, v64, v65
    v_cvt_pk_bf16_f32 v41, v66, v67
    v_mfma_f32_32x32x16_bf16 v[48:63], v[16:19], v[8:11], 0
    v_exp_f32 v72, v72
    v_cvt_pk_bf16_f32 v42, v68, v69
    v_cvt_pk_bf16_f32 v43, v70, v71
    v_exp_f32 v73, v73
    v_exp_f32 v74, v74
    v_exp_f32 v75, v75
    v_exp_f32 v76, v76
    v_mfma_f32_32x32x16_bf16 v[96:111], v[32:35], v[40:43], v[96:111]
    v_exp_f32 v77, v77
    v_exp_f32 v78, v78
    v_exp_f32 v79, v79
    v_cvt_pk_bf16_f32 v44, v72, v73
    v_cvt_pk_bf16_f32 v45, v74, v75
    v_cvt_pk_bf16_f32 v46, v76, v77
    v_cvt_pk_bf16_f32 v47, v78, v79
    v_add_u32 v2, 16384, v2
    v_add_u32 v5, 4, v5
    s_add_u32 s55, s55, 1
    s_cmp_lt_u32 s55, 8
    ds_write_b32 v6, v5 offset:80
    s_cbranch_scc1 M_BLOOP
M_EPI:
    ds_read_b32 v4, v6 offset:48
    ds_read_b32 v16, v3
    ds_read_b32 v17, v3 offset:128
    v_mfma_f32_32x32x16_bf16 v[96:111], v[36:39], v[44:47], v[96:111]
    s_mov_b32 s40, 0x71800000
    s_mov_b32 s41, 0x30800000
    v_add_f32 v2, |v80|, |v81|
    v_add_f32 v5, |v82|, |v83|
    v_add_f32 v2, v2, |v84|
    v_add_f32 v5, v5, |v85|
    v_add_f32 v2, v2, |v86|
    v_add_f32 v5, v5, |v87|
    v_add_f32 v2, v2, v88
    v_add_f32 v2, v2, v5
    v_rcp_f32 v5, v88
    v_cmp_nlt_f32 vcc, v2, s40
    v_cmp_nge_f32 s[42:43], v88, s41
    s_waitcnt lgkmcnt(0)
    v_readfirstlane_b32 s44, v4
    s_cmp_eq_u32 s44, 0
    s_cbranch_scc1 M_GW
M_GWD:
    v_mul_f32 v5, v5, v16
    s_or_b64 vcc, vcc, s[42:43]
    s_cselect_b32 s44, s54, 1
    s_cmp_eq_u32 s44, 0
    s_cbranch_scc1 M_SLOW
    v_mul_f32 v80, v5, v80
    v_mul_f32 v81, v5, v81
    v_mul_f32 v82, v5, v82
    v_mul_f32 v83, v5, v83
    v_mul_f32 v84, v5, v84
    v_mul_f32 v85, v5, v85
    v_mul_f32 v86, v5, v86
    v_mul_f32 v87, v5, v87
    v_cvt_pk_bf16_f32 v48, v80, v81
    v_cvt_pk_bf16_f32 v49, v82, v83
    v_cvt_pk_bf16_f32 v50, v84, v85
    v_cvt_pk_bf16_f32 v51, v86, v87
    v_min_u32 v48, -2, v48
    v_min_u32 v49, -2, v49
    v_min_u32 v50, -2, v50
    v_min_u32 v51, -2, v51
    buffer_store_dwordx4 v[48:51], v1, s[16:19], s60 offen sc1
    v_add_f32 v2, |v96|, |v97|
    v_add_f32 v5, |v98|, |v99|
    v_add_f32 v2, v2, |v100|
    v_add_f32 v5, v5, |v101|
    v_add_f32 v2, v2, |v102|
    v_add_f32 v5, v5, |v103|
    v_add_f32 v2, v2, v104
    v_add_f32 v2, v2, v5
    v_rcp_f32 v5, v104
    v_cmp_nlt_f32 vcc, v2, s40
    v_cmp_nge_f32 s[42:43], v104, s41
    v_mul_f32 v5, v5, v17
    s_or_b64 vcc, vcc, s[42:43]
    s_cselect_b32 s44, s54, 1
    s_cmp_eq_u32 s44, 0
    s_cbranch_scc1 M_SLOW
    v_mul_f32 v96, v5, v96
    v_mul_f32 v97, v5, v97
    v_mul_f32 v98, v5, v98
    v_mul_f32 v99, v5, v99
    v_mul_f32 v100, v5, v100
    v_mul_f32 v101, v5, v101
    v_mul_f32 v102, v5, v102
    v_mul_f32 v103, v5, v103
    v_cvt_pk_bf16_f32 v64, v96, v97
    v_cvt_pk_bf16_f32 v65, v98, v99
    v_cvt_pk_bf16_f32 v66, v100, v101
    v_cvt_pk_bf16_f32 v67, v102, v103
    v_min_u32 v64, -2, v64
    v_min_u32 v65, -2, v65
    v_min_u32 v66, -2, v66
    v_min_u32 v67, -2, v67
    buffer_store_dwordx4 v[64:67], v1, s[16:19], s61 offen sc1
    s_endpgm
M_GW:
    s_sleep 1
    ds_read_b32 v4, v6 offset:48
    ds_read_b32 v16, v3
    ds_read_b32 v17, v3 offset:128
    s_waitcnt lgkmcnt(0)
    v_readfirstlane_b32 s44, v4
    s_cmp_eq_u32 s44, 0
    s_cbranch_scc1 M_GW
    s_branch M_GWD
M_P2:
    s_cmp_eq_u32 s41, 15
    s_cbranch_scc0 M_P20
    v_lshlrev_b32 v2, 2, v0
    v_cmp_eq_u32 vcc, 8, v0
    v_mov_b32 v3, 0
    v_add_u32 v2, 135168, v2
    v_cndmask_b32 v3, v3, 4, vcc
    ds_write_b32 v2, v3
M_P20:
    s_cmp_eq_u32 s41, 10
    s_cbranch_scc0 M_P21
    s_mov_b32 s43, 0
M_F01:
    s_waitcnt vmcnt(0)
    v_readfirstlane_b32 s40, v47
    s_add_u32 s43, s43, 1
    s_cmp_lg_u32 s40, 0
    s_cbranch_scc1 M_F02
    buffer_load_dword v47, v22, s[72:75], 0 offen sc1
    s_cmp_lt_u32 s43, 65536
    s_cbranch_scc1 M_F01
M_F02:
    s_mov_b64 exec, 1
    buffer_store_dword v47, v22, s[16:19], s62 offen sc1
    s_mov_b64 exec, -1
    s_branch M_P2D
M_P21:
    s_cmp_eq_u32 s41, 12
    s_cbranch_scc0 M_P22
    buffer_load_dword v23, v22, s[16:19], s85 offen sc1
    s_branch M_P2D
M_P22:
    s_cmp_eq_u32 s41, 15
    s_cbranch_scc0 M_P2D
    s_waitcnt vmcnt(0)
    v_cmp_eq_u32 vcc, v47, v23
    s_nop 3
    s_mov_b32 s84, vcc_lo
    s_cmp_lg_u32 s84, 0
    s_cbranch_scc1 M_P23
    buffer_load_dword v23, v22, s[16:19], s85 offen sc1
    s_branch M_P2D
M_P23:
    buffer_load_dwordx4 v[8:11], v1, s[16:19], s86 offen sc1
    buffer_load_dwordx4 v[12:15], v1, s[16:19], s86 offen offset:1024 sc1
    s_branch M_P2D
M_SPIN:
M_SPIN2:
    ds_read_b32 v4, v5
    s_waitcnt lgkmcnt(0)
    v_readfirstlane_b32 s40, v4
    s_cmp_ge_u32 s40, 4
    s_cbranch_scc1 M_SPIND
    s_sleep 1
    s_branch M_SPIN2
M_SLOW:
    s_mov_b32 s54, 1
    v_and_b32 v2, 27, v0
    v_cmp_eq_u32 vcc, 16, v2
    v_mov_b32 v2, 0
    v_mov_b32 v3, 0x3f803f80
    s_nop 0
    v_cndmask_b32 v2, v2, v3, vcc
    v_mov_b32 v3, v2
    v_mov_b64 v[24:25], v[2:3]
    v_mov_b64 v[26:27], v[2:3]
    v_mov_b64 v[28:29], v[2:3]
    v_mov_b64 v[30:31], v[2:3]
    v_mov_b64 v[32:33], v[2:3]
    v_mov_b64 v[34:35], v[2:3]
    v_mov_b64 v[36:37], v[2:3]
    v_mov_b64 v[38:39], v[2:3]
    v_mov_b64 v[80:81], 0
    v_mov_b64 v[82:83], 0
    v_mov_b64 v[84:85], 0
    v_mov_b64 v[86:87], 0
    v_mov_b64 v[88:89], 0
    v_mov_b64 v[90:91], 0
    v_mov_b64 v[92:93], 0
    v_mov_b64 v[94:95], 0
    v_mov_b64 v[96:97], 0
    v_mov_b64 v[98:99], 0
    v_mov_b64 v[100:101], 0
    v_mov_b64 v[102:103], 0
    v_mov_b64 v[104:105], 0
    v_mov_b64 v[106:107], 0
    v_mov_b64 v[108:109], 0
    v_mov_b64 v[110:111], 0
    v_mov_b32 v2, 0xff800000
    v_mov_b32 v3, 0xff800000
    s_lshl_b32 s55, s34, 17
    s_add_u32 s56, s55, 0x20000
M_SL:
    buffer_load_dwordx4 v[16:19], v1, s[16:19], s55 offen sc1
    s_add_u32 s55, s55, 2048
    s_waitcnt vmcnt(0)
    v_mfma_f32_32x32x16_bf16 v[48:63], v[16:19], v[8:11], 0
    v_mfma_f32_32x32x16_bf16 v[64:79], v[16:19], v[12:15], 0
    s_nop 7
    s_nop 7
    s_nop 7
    v_max3_f32 v2, v2, v48, v49
    v_max3_f32 v2, v2, v50, v51
    v_max3_f32 v2, v2, v52, v53
    v_max3_f32 v2, v2, v54, v55
    v_max3_f32 v2, v2, v56, v57
    v_max3_f32 v2, v2, v58, v59
    v_max3_f32 v2, v2, v60, v61
    v_max3_f32 v2, v2, v62, v63
    v_max3_f32 v3, v3, v64, v65
    v_max3_f32 v3, v3, v66, v67
    v_max3_f32 v3, v3, v68, v69
    v_max3_f32 v3, v3, v70, v71
    v_max3_f32 v3, v3, v72, v73
    v_max3_f32 v3, v3, v74, v75
    v_max3_f32 v3, v3, v76, v77
    v_max3_f32 v3, v3, v78, v79
    s_cmp_lt_u32 s55, s56
    s_cbranch_scc1 M_SL
    v_mov_b32 v40, v2
    v_mov_b32 v41, v3
    s_nop 1
    v_permlane32_swap_b32 v2, v40
    v_permlane32_swap_b32 v3, v41
    s_nop 1
    v_max_f32 v40, v2, v40
    v_max_f32 v41, v3, v41
    s_lshl_b32 s55, s34, 17
    v_sub_f32 v112, 0, v40
    v_sub_f32 v113, 0, v40
    v_sub_f32 v114, 0, v40
    v_sub_f32 v115, 0, v40
    v_sub_f32 v116, 0, v40
    v_sub_f32 v117, 0, v40
    v_sub_f32 v118, 0, v40
    v_sub_f32 v119, 0, v40
    v_sub_f32 v120, 0, v40
    v_sub_f32 v121, 0, v40
    v_sub_f32 v122, 0, v40
    v_sub_f32 v123, 0, v40
    v_sub_f32 v124, 0, v40
    v_sub_f32 v125, 0, v40
    v_sub_f32 v126, 0, v40
    v_sub_f32 v127, 0, v40
    v_sub_f32 v128, 0, v41
    v_sub_f32 v129, 0, v41
    v_sub_f32 v130, 0, v41
    v_sub_f32 v131, 0, v41
    v_sub_f32 v132, 0, v41
    v_sub_f32 v133, 0, v41
    v_sub_f32 v134, 0, v41
    v_sub_f32 v135, 0, v41
    v_sub_f32 v136, 0, v41
    v_sub_f32 v137, 0, v41
    v_sub_f32 v138, 0, v41
    v_sub_f32 v139, 0, v41
    v_sub_f32 v140, 0, v41
    v_sub_f32 v141, 0, v41
    v_sub_f32 v142, 0, v41
    v_sub_f32 v143, 0, v41
M_SLOOP:
    buffer_load_dwordx4 v[16:19], v1, s[16:19], s55 offen sc1
    s_mov_b64 exec, s[52:53]
    buffer_load_dwordx4 v[24:27], v1, s[16:19], s55 offen offset:1024 sc1
    buffer_load_dwordx4 v[28:31], v1, s[16:19], s55 offen offset:1280 sc1
    s_mov_b64 exec, -1
    s_add_u32 s55, s55, 2048
    s_waitcnt vmcnt(0)
    v_mfma_f32_32x32x16_bf16 v[48:63], v[16:19], v[8:11], v[112:127]
    v_mfma_f32_32x32x16_bf16 v[64:79], v[16:19], v[12:15], v[128:143]
    s_nop 7
    s_nop 7
    s_nop 7
    v_exp_f32 v48, v48
    v_exp_f32 v49, v49
    v_exp_f32 v50, v50
    v_exp_f32 v51, v51
    v_exp_f32 v52, v52
    v_exp_f32 v53, v53
    v_exp_f32 v54, v54
    v_exp_f32 v55, v55
    v_exp_f32 v56, v56
    v_exp_f32 v57, v57
    v_exp_f32 v58, v58
    v_exp_f32 v59, v59
    v_exp_f32 v60, v60
    v_exp_f32 v61, v61
    v_exp_f32 v62, v62
    v_exp_f32 v63, v63
    s_nop 1
    v_cvt_pk_bf16_f32 v40, v48, v49
    v_cvt_pk_bf16_f32 v41, v50, v51
    v_cvt_pk_bf16_f32 v42, v52, v53
    v_cvt_pk_bf16_f32 v43, v54, v55
    v_cvt_pk_bf16_f32 v44, v56, v57
    v_cvt_pk_bf16_f32 v45, v58, v59
    v_cvt_pk_bf16_f32 v46, v60, v61
    v_cvt_pk_bf16_f32 v47, v62, v63
    s_nop 3
    v_mfma_f32_32x32x16_bf16 v[80:95], v[24:27], v[40:43], v[80:95]
    s_nop 3
    v_mfma_f32_32x32x16_bf16 v[80:95], v[28:31], v[44:47], v[80:95]
    v_exp_f32 v64, v64
    v_exp_f32 v65, v65
    v_exp_f32 v66, v66
    v_exp_f32 v67, v67
    v_exp_f32 v68, v68
    v_exp_f32 v69, v69
    v_exp_f32 v70, v70
    v_exp_f32 v71, v71
    v_exp_f32 v72, v72
    v_exp_f32 v73, v73
    v_exp_f32 v74, v74
    v_exp_f32 v75, v75
    v_exp_f32 v76, v76
    v_exp_f32 v77, v77
    v_exp_f32 v78, v78
    v_exp_f32 v79, v79
    s_nop 1
    v_cvt_pk_bf16_f32 v40, v64, v65
    v_cvt_pk_bf16_f32 v41, v66, v67
    v_cvt_pk_bf16_f32 v42, v68, v69
    v_cvt_pk_bf16_f32 v43, v70, v71
    v_cvt_pk_bf16_f32 v44, v72, v73
    v_cvt_pk_bf16_f32 v45, v74, v75
    v_cvt_pk_bf16_f32 v46, v76, v77
    v_cvt_pk_bf16_f32 v47, v78, v79
    s_nop 3
    v_mfma_f32_32x32x16_bf16 v[96:111], v[24:27], v[40:43], v[96:111]
    s_nop 3
    v_mfma_f32_32x32x16_bf16 v[96:111], v[28:31], v[44:47], v[96:111]
    s_cmp_lt_u32 s55, s56
    s_cbranch_scc1 M_SLOOP
    s_nop 7
    s_nop 7
    s_nop 7
    v_and_b32 v3, 31, v0
    s_lshl_b32 s40, s36, 8
    s_add_u32 s40, s40, 161792
    v_lshl_add_u32 v3, v3, 2, s40
    v_mov_b32 v44, 0
    v_mov_b32 v45, 0
    v_mov_b32 v46, 0
    v_mov_b32 v47, 0
    s_nop 3
    s_branch M_EPI
M_END:
    s_endpgm
.section .rodata,"a"
.p2align 6
.amdhsa_kernel gated_mix__mha_block__dense_activation_relu__prompt_kernel
  .amdhsa_next_free_vgpr 256
  .amdhsa_next_free_sgpr 102
  .amdhsa_accum_offset 256
  .amdhsa_group_segment_fixed_size 0
  .amdhsa_kernarg_size 80
  .amdhsa_user_sgpr_count 2
  .amdhsa_user_sgpr_kernarg_segment_ptr 1
  .amdhsa_system_sgpr_workgroup_id_x 1
.end_amdhsa_kernel
```
